```python
import torch

def _softmax(x, axis=-1):
    return torch.softmax(x, dim=axis)
def _gelu(x):
    return torch.nn.functional.gelu(x, approximate="tanh")
def _silu(x):
    return torch.nn.functional.silu(x)
def _sigmoid(x):
    return torch.sigmoid(x)
def _layernorm(x, axis=-1, eps=1e-5):
    m = x.mean(dim=axis, keepdim=True)
    v = x.var(dim=axis, keepdim=True, unbiased=False)
    return (x - m) / torch.sqrt(v + eps)
def _scatter_add(tgt, idx, src, axis=0):
    return tgt.clone().index_add_(axis, idx, src)
def _segment_sum(src, seg, n):
    out = torch.zeros((n,) + src.shape[1:], dtype=src.dtype)
    return out.index_add_(0, seg, src)
def _pad(x, pw):
    flat = tuple(v for pair in reversed(pw) for v in pair)
    return torch.nn.functional.pad(x, flat)

kernel_name = 'sequential_preLN__gqa_block_cached__dense_activation_relu__decode'

def setup_inputs():

    _w = (lambda a: (lambda t: t.to(torch.bfloat16) if t.is_floating_point() else t)(torch.as_tensor(a)))
    def _A_setup():
        B, Sq, D = 4, 1, 512
        Hq, Hkv, Sk, Dh = 32, 32, 8192, 128
        assert Hq % Hkv == 0, (Hq, Hkv)
        return {
            "x": _w((lambda *s: torch.randn(*s, dtype=torch.bfloat16) * 0.05)(B, Sq, D)),
            "k_cache": _w((lambda *s: torch.randn(*s, dtype=torch.bfloat16) * 3.2)(B, Hkv, Sk, Dh)),
            "v_cache": _w((lambda *s: torch.randn(*s, dtype=torch.bfloat16) * 0.4)(B, Hkv, Sk, Dh)),
            "wq": _w((lambda *s: torch.randn(*s, dtype=torch.bfloat16) * 3.2)(D, Hq * Dh) * (D ** -0.5)),
            "wo": _w((lambda *s: torch.randn(*s, dtype=torch.bfloat16) * 0.4)(Hq * Dh, D) * ((Hq * Dh) ** -0.5)),
        }
    _A_in = _A_setup()

    def _B_setup():
        B, S, D, Dff = 4, 1, 512, 1376
        return {
            "x": _w((lambda *s: torch.randn(*s, dtype=torch.bfloat16) * 0.05)(B, S, D)),
            "w1": _w((lambda *s: torch.randn(*s, dtype=torch.bfloat16) * 0.05)(D, Dff)),
            "w2": _w((lambda *s: torch.randn(*s, dtype=torch.bfloat16) * 0.05)(Dff, D)),
        }
    _B_in = _B_setup()

    return {
        "A_x": _A_in["x"],
        "A_k_cache": _A_in["k_cache"],
        "A_v_cache": _A_in["v_cache"],
        "A_wq": _A_in["wq"],
        "A_wo": _A_in["wo"],
        "B_x": _B_in["x"],
        "B_w1": _B_in["w1"],
        "B_w2": _B_in["w2"],
    }

def reference(A_x, A_k_cache, A_v_cache, A_wq, A_wo, B_x, B_w1, B_w2):
    def _A_ref(x, k_cache, v_cache, wq, wo):
        B, Sq, D = x.shape
        Hq, Dh = 32, 128
        Hkv = k_cache.shape[1]
        rep = Hq // Hkv
        q = (lambda x, *d: x.permute(*d))((x @ wq).reshape(B, Sq, Hq, Dh), 0, 2, 1, 3)
        k = (lambda x, n, axis: torch.repeat_interleave(x, n, dim=axis))(k_cache, rep, axis=1)
        v = (lambda x, n, axis: torch.repeat_interleave(x, n, dim=axis))(v_cache, rep, axis=1)
        scores = torch.einsum("bhqd,bhkd->bhqk", q, k) * (Dh ** -0.5)
        p = _softmax(scores, axis=-1)
        o = torch.einsum("bhqk,bhkd->bhqd", p, v)
        return (lambda x, *d: x.permute(*d))(o, 0, 2, 1, 3).reshape(B, Sq, Hq * Dh) @ wo

    def _B_ref(x, w1, w2):
        h = torch.einsum("bsd,df->bsf", x, w1)
        zero = torch.zeros_like(h)
        h = torch.maximum(h, zero)
        return torch.einsum("bsf,fd->bsd", h, w2)

    x = A_x
    h = x + _A_ref(_layernorm(x, axis=-1), A_k_cache, A_v_cache, A_wq, A_wo)
    h2 = h + _B_ref(_layernorm(h, axis=-1), B_w1, B_w2)
    return h2
```

```asm
; @launch grid=(256,1,1) block=(256,1,1) lds=65536
.amdgcn_target "amdgcn-amd-amdhsa--gfx950"
.text
.globl sequential_preLN__gqa_block_cached__dense_activation_relu__decode_kernel
.p2align 8
.type sequential_preLN__gqa_block_cached__dense_activation_relu__decode_kernel,@function
sequential_preLN__gqa_block_cached__dense_activation_relu__decode_kernel:
  s_cmp_ge_u32 s2, 256
  s_cbranch_scc1 L_exit
  s_load_dwordx16 s[4:19], s[0:1], 0
  s_load_dwordx4 s[20:23], s[0:1], 64
  s_load_dwordx2 s[24:25], s[0:1], 80
  s_getpc_b64 s[88:89]
  v_lshlrev_b32 v45, 6, v0
  global_load_dword v254, v45, s[88:89]
  v_and_b32 v1, 63, v0
  v_lshrrev_b32 v30, 6, v0
  v_lshlrev_b32 v2, 4, v1
  v_readfirstlane_b32 s26, v30
  v_lshrrev_b32 v3, 4, v1
  v_and_b32 v4, 15, v1
  s_and_b32 s72, s2, 7
  s_lshr_b32 s73, s2, 3
  s_lshr_b32 s27, s72, 2
  s_xor_b32 s74, s72, 5
  s_cmp_lt_u32 s72, 4
  s_cselect_b32 s74, s72, s74
  s_and_b32 s68, s73, 28
  s_add_u32 s68, s68, s74
  s_and_b32 s69, s73, 3
  s_lshl_b32 s70, s69, 5
  s_add_u32 s70, s70, s68
  v_lshlrev_b32 v31, 4, v4
  v_lshl_add_u32 v6, v3, 13, v31
  v_lshl_add_u32 v5, v3, 10, v31
  s_lshl_b32 s75, s27, 2
  s_add_u32 s75, s75, s26
  s_lshl_b32 s86, s75, 12
  s_add_u32 s87, s86, 32768
  s_add_u32 s80, s86, 131072
  s_add_u32 s100, s86, 65536
  s_add_u32 s101, s86, 98304
  s_lshl_b32 s76, s70, 21
  s_lshl_b32 s77, s26, 20
  s_lshl_b32 s78, s68, 8
  s_add_u32 s77, s77, s78
  s_lshl_b32 s78, s69, 10
  s_waitcnt lgkmcnt(0)
  s_mov_b32 s52, s4
  s_mov_b32 s53, s5
  s_mov_b32 s54, 0x1000
  s_mov_b32 s55, 0x20000
  s_mov_b32 s36, s10
  s_mov_b32 s37, s11
  s_mov_b32 s38, 0x400000
  s_mov_b32 s39, 0x20000
  buffer_load_dwordx4 v[160:163], v2, s[52:55], s78 offen
  s_add_u32 s28, s6, s76
  s_addc_u32 s29, s7, 0
  s_mov_b32 s30, 0x200000
  s_mov_b32 s31, 0x20000
  buffer_load_dwordx4 v[48:51], v2, s[28:31], s86 offen offset:0 nt
  buffer_load_dwordx4 v[52:55], v2, s[28:31], s86 offen offset:1024 nt
  buffer_load_dwordx4 v[56:59], v2, s[28:31], s86 offen offset:2048 nt
  buffer_load_dwordx4 v[60:63], v2, s[28:31], s86 offen offset:3072 nt
  s_add_u32 s32, s8, s76
  s_addc_u32 s33, s9, 0
  s_mov_b32 s34, 0x200000
  s_mov_b32 s35, 0x20000
  buffer_load_dwordx4 a[0:3], v6, s[36:39], s77 offen
  s_add_u32 s77, s77, 32768
  buffer_load_dwordx4 a[4:7], v6, s[36:39], s77 offen
  s_add_u32 s77, s77, 32768
  buffer_load_dwordx4 a[8:11], v6, s[36:39], s77 offen
  s_add_u32 s77, s77, 32768
  buffer_load_dwordx4 a[12:15], v6, s[36:39], s77 offen
  s_add_u32 s77, s77, 32768
  buffer_load_dwordx4 a[16:19], v6, s[36:39], s77 offen
  s_add_u32 s77, s77, 32768
  buffer_load_dwordx4 a[20:23], v6, s[36:39], s77 offen
  s_add_u32 s77, s77, 32768
  buffer_load_dwordx4 a[24:27], v6, s[36:39], s77 offen
  s_add_u32 s77, s77, 32768
  buffer_load_dwordx4 a[28:31], v6, s[36:39], s77 offen
  s_add_u32 s77, s77, 32768
  v_and_b32 v30, 1, v4
  v_mov_b32 v31, 0xffff
  v_lshlrev_b32 v30, 4, v30
  v_lshlrev_b32 v31, v30, v31
  v_bfe_u32 v32, v4, 1, 2
  v_cmp_eq_u32 vcc, 0, v32
  s_nop 1
  v_cndmask_b32 v8, 0, v31, vcc
  v_cmp_eq_u32 vcc, 1, v32
  s_nop 1
  v_cndmask_b32 v9, 0, v31, vcc
  v_cmp_eq_u32 vcc, 2, v32
  s_nop 1
  v_cndmask_b32 v10, 0, v31, vcc
  v_cmp_eq_u32 vcc, 3, v32
  s_nop 1
  v_cndmask_b32 v11, 0, v31, vcc
  v_mov_b32 v16, 0
  v_mov_b32 v17, 0
  v_mov_b32 v18, 0
  v_mov_b32 v19, 0
  v_mov_b32 v20, 0
  v_mov_b32 v21, 0
  v_mov_b32 v22, 0
  v_mov_b32 v23, 0
  v_mov_b32 v25, 0
  v_mov_b32 v24, 0xff800000
  v_mov_b32 v46, 0
  s_waitcnt vmcnt(12)
  v_lshlrev_b32 v164, 16, v160
  v_and_b32 v165, 0xffff0000, v160
  v_lshlrev_b32 v166, 16, v161
  v_and_b32 v167, 0xffff0000, v161
  v_lshlrev_b32 v168, 16, v162
  v_and_b32 v169, 0xffff0000, v162
  v_lshlrev_b32 v170, 16, v163
  v_and_b32 v171, 0xffff0000, v163
  v_readfirstlane_b32 s73, v164
  s_nop 1
  v_subrev_f32 v204, s73, v164
  v_subrev_f32 v205, s73, v165
  v_subrev_f32 v206, s73, v166
  v_subrev_f32 v207, s73, v167
  v_subrev_f32 v208, s73, v168
  v_subrev_f32 v209, s73, v169
  v_subrev_f32 v210, s73, v170
  v_subrev_f32 v211, s73, v171
  v_add_f32 v172, v204, v205
  v_mul_f32 v173, v204, v204
  v_add_f32 v174, v206, v207
  v_mul_f32 v176, v205, v205
  v_add_f32 v175, v208, v209
  v_fmac_f32 v173, v206, v206
  v_add_f32 v172, v172, v174
  v_fmac_f32 v176, v207, v207
  v_add_f32 v174, v210, v211
  v_fmac_f32 v173, v208, v208
  v_add_f32 v175, v175, v174
  v_fmac_f32 v176, v209, v209
  v_add_f32 v172, v172, v175
  v_fmac_f32 v173, v210, v210
  v_fmac_f32 v176, v211, v211
  v_add_f32 v173, v173, v176
  v_add_f32_dpp v172, v172, v172 row_ror:8 row_mask:0xf bank_mask:0xf
  s_nop 0
  v_add_f32_dpp v173, v173, v173 row_ror:8 row_mask:0xf bank_mask:0xf
  v_add_f32_dpp v172, v172, v172 row_ror:4 row_mask:0xf bank_mask:0xf
  s_nop 0
  v_add_f32_dpp v173, v173, v173 row_ror:4 row_mask:0xf bank_mask:0xf
  v_add_f32_dpp v172, v172, v172 row_ror:2 row_mask:0xf bank_mask:0xf
  s_nop 0
  v_add_f32_dpp v173, v173, v173 row_ror:2 row_mask:0xf bank_mask:0xf
  v_add_f32_dpp v172, v172, v172 row_ror:1 row_mask:0xf bank_mask:0xf
  s_nop 0
  v_add_f32_dpp v173, v173, v173 row_ror:1 row_mask:0xf bank_mask:0xf
  v_mov_b32 v174, v172
  buffer_load_dwordx4 v[64:67], v2, s[32:35], s86 offen offset:0 nt
  buffer_load_dwordx4 v[68:71], v2, s[32:35], s86 offen offset:1024 nt
  buffer_load_dwordx4 v[72:75], v2, s[32:35], s86 offen offset:2048 nt
  buffer_load_dwordx4 v[76:79], v2, s[32:35], s86 offen offset:3072 nt
  buffer_load_dwordx4 a[32:35], v6, s[36:39], s77 offen
  s_add_u32 s77, s77, 32768
  buffer_load_dwordx4 a[36:39], v6, s[36:39], s77 offen
  s_add_u32 s77, s77, 32768
  buffer_load_dwordx4 a[40:43], v6, s[36:39], s77 offen
  s_add_u32 s77, s77, 32768
  buffer_load_dwordx4 a[44:47], v6, s[36:39], s77 offen
  s_add_u32 s77, s77, 32768
  buffer_load_dwordx4 a[48:51], v6, s[36:39], s77 offen
  s_add_u32 s77, s77, 32768
  buffer_load_dwordx4 a[52:55], v6, s[36:39], s77 offen
  s_add_u32 s77, s77, 32768
  buffer_load_dwordx4 a[56:59], v6, s[36:39], s77 offen
  s_add_u32 s77, s77, 32768
  buffer_load_dwordx4 a[60:63], v6, s[36:39], s77 offen
  s_add_u32 s77, s77, 32768
  v_mov_b32 v175, v173
  v_permlane16_swap_b32 v172, v174
  s_nop 0
  v_permlane16_swap_b32 v173, v175
  v_add_f32 v172, v172, v174
  v_add_f32 v173, v173, v175
  v_mov_b32 v174, v172
  v_mov_b32 v175, v173
  s_nop 0
  v_permlane32_swap_b32 v172, v174
  v_permlane32_swap_b32 v173, v175
  v_add_f32 v172, v172, v174
  v_add_f32 v173, v173, v175
  v_mul_f32 v172, 0x3b000000, v172
  v_mul_f32 v173, 0x3b000000, v173
  v_add_f32 v174, s73, v172
  v_fma_f32 v173, -v172, v172, v173
  v_cvt_pk_bf16_f32 v174, v174, v174
  v_and_b32 v174, 0xffff0000, v174
  v_max_f32 v173, 0, v173
  v_cvt_pk_bf16_f32 v173, v173, v173
  v_and_b32 v173, 0xffff0000, v173
  v_add_f32 v173, 0x3727c5ac, v173
  v_cvt_pk_bf16_f32 v173, v173, v173
  v_and_b32 v173, 0xffff0000, v173
  v_sqrt_f32 v173, v173
  v_sub_f32 v164, v164, v174
  v_sub_f32 v165, v165, v174
  v_sub_f32 v166, v166, v174
  v_sub_f32 v167, v167, v174
  v_sub_f32 v168, v168, v174
  v_sub_f32 v169, v169, v174
  v_sub_f32 v170, v170, v174
  v_sub_f32 v171, v171, v174
  v_cvt_pk_bf16_f32 v173, v173, v173
  v_and_b32 v173, 0xffff0000, v173
  v_rcp_f32 v176, v173
  v_cvt_pk_bf16_f32 v164, v164, v164
  v_and_b32 v164, 0xffff0000, v164
  v_cvt_pk_bf16_f32 v165, v165, v165
  v_and_b32 v165, 0xffff0000, v165
  v_cvt_pk_bf16_f32 v166, v166, v166
  v_and_b32 v166, 0xffff0000, v166
  v_cvt_pk_bf16_f32 v167, v167, v167
  buffer_load_dwordx4 v[80:83], v2, s[28:31], s87 offen offset:0 nt
  buffer_load_dwordx4 v[84:87], v2, s[28:31], s87 offen offset:1024 nt
  buffer_load_dwordx4 v[88:91], v2, s[28:31], s87 offen offset:2048 nt
  buffer_load_dwordx4 v[92:95], v2, s[28:31], s87 offen offset:3072 nt
  buffer_load_dwordx4 a[64:67], v6, s[36:39], s77 offen
  s_add_u32 s77, s77, 32768
  buffer_load_dwordx4 a[68:71], v6, s[36:39], s77 offen
  s_add_u32 s77, s77, 32768
  buffer_load_dwordx4 a[72:75], v6, s[36:39], s77 offen
  s_add_u32 s77, s77, 32768
  buffer_load_dwordx4 a[76:79], v6, s[36:39], s77 offen
  s_add_u32 s77, s77, 32768
  buffer_load_dwordx4 a[80:83], v6, s[36:39], s77 offen
  s_add_u32 s77, s77, 32768
  buffer_load_dwordx4 a[84:87], v6, s[36:39], s77 offen
  s_add_u32 s77, s77, 32768
  buffer_load_dwordx4 a[88:91], v6, s[36:39], s77 offen
  s_add_u32 s77, s77, 32768
  buffer_load_dwordx4 a[92:95], v6, s[36:39], s77 offen
  s_add_u32 s77, s77, 32768
  v_and_b32 v167, 0xffff0000, v167
  v_cvt_pk_bf16_f32 v168, v168, v168
  v_and_b32 v168, 0xffff0000, v168
  v_cvt_pk_bf16_f32 v169, v169, v169
  v_and_b32 v169, 0xffff0000, v169
  v_cvt_pk_bf16_f32 v170, v170, v170
  v_and_b32 v170, 0xffff0000, v170
  v_cvt_pk_bf16_f32 v171, v171, v171
  v_and_b32 v171, 0xffff0000, v171
  v_mul_f32 v164, v164, v176
  v_mul_f32 v165, v165, v176
  v_mul_f32 v166, v166, v176
  v_mul_f32 v167, v167, v176
  v_mul_f32 v168, v168, v176
  v_mul_f32 v169, v169, v176
  v_mul_f32 v170, v170, v176
  v_mul_f32 v171, v171, v176
  v_cvt_pk_bf16_f32 v112, v164, v164
  v_cvt_pk_bf16_f32 v113, v168, v168
  v_cvt_pk_bf16_f32 v114, v165, v165
  v_cvt_pk_bf16_f32 v115, v169, v169
  v_cvt_pk_bf16_f32 v116, v166, v166
  v_cvt_pk_bf16_f32 v117, v170, v170
  v_cvt_pk_bf16_f32 v118, v167, v167
  v_cvt_pk_bf16_f32 v119, v171, v171
  v_lshlrev_b32 v172, 3, v1
  ds_write_b64 v172, v[112:113] offset:0
  ds_write_b64 v172, v[114:115] offset:528
  ds_write_b64 v172, v[116:117] offset:1056
  ds_write_b64 v172, v[118:119] offset:1584
  v_mul_u32_u24 v173, 528, v3
  s_lshl_b32 s72, s26, 7
  v_add_u32 v173, s72, v173
  s_waitcnt lgkmcnt(0)
  ds_read_b128 v[112:115], v173 offset:0
  ds_read_b128 v[116:119], v173 offset:16
  ds_read_b128 v[120:123], v173 offset:32
  ds_read_b128 v[124:127], v173 offset:48
  ds_read_b128 v[128:131], v173 offset:64
  ds_read_b128 v[132:135], v173 offset:80
  ds_read_b128 v[136:139], v173 offset:96
  ds_read_b128 v[140:143], v173 offset:112
  buffer_load_dwordx4 v[96:99], v2, s[32:35], s87 offen offset:0 nt
  buffer_load_dwordx4 v[100:103], v2, s[32:35], s87 offen offset:1024 nt
  buffer_load_dwordx4 v[104:107], v2, s[32:35], s87 offen offset:2048 nt
  buffer_load_dwordx4 v[108:111], v2, s[32:35], s87 offen offset:3072 nt
  buffer_load_dwordx4 a[96:99], v6, s[36:39], s77 offen
  s_add_u32 s77, s77, 32768
  buffer_load_dwordx4 a[100:103], v6, s[36:39], s77 offen
  s_add_u32 s77, s77, 32768
  buffer_load_dwordx4 a[104:107], v6, s[36:39], s77 offen
  s_add_u32 s77, s77, 32768
  buffer_load_dwordx4 a[108:111], v6, s[36:39], s77 offen
  s_add_u32 s77, s77, 32768
  buffer_load_dwordx4 a[112:115], v6, s[36:39], s77 offen
  s_add_u32 s77, s77, 32768
  buffer_load_dwordx4 a[116:119], v6, s[36:39], s77 offen
  s_add_u32 s77, s77, 32768
  buffer_load_dwordx4 a[120:123], v6, s[36:39], s77 offen
  s_add_u32 s77, s77, 32768
  buffer_load_dwordx4 a[124:127], v6, s[36:39], s77 offen
  s_waitcnt lgkmcnt(0)
  v_and_b32 v144, v112, v8
  v_and_b32 v145, v112, v9
  v_and_b32 v146, v112, v10
  v_and_b32 v147, v112, v11
  v_and_b32 v148, v113, v8
  v_and_b32 v149, v113, v9
  v_and_b32 v150, v113, v10
  v_and_b32 v151, v113, v11
  s_waitcnt vmcnt(40)
  v_mfma_f32_16x16x32_bf16 v[152:155], v[144:147], a[0:3], 0
  v_and_b32 v144, v114, v8
  v_and_b32 v145, v114, v9
  v_and_b32 v146, v114, v10
  v_and_b32 v147, v114, v11
  v_mfma_f32_16x16x32_bf16 v[152:155], v[148:151], a[4:7], v[152:155]
  v_and_b32 v148, v115, v8
  v_and_b32 v149, v115, v9
  v_and_b32 v150, v115, v10
  v_and_b32 v151, v115, v11
  v_mfma_f32_16x16x32_bf16 v[152:155], v[144:147], a[8:11], v[152:155]
  v_and_b32 v144, v116, v8
  v_and_b32 v145, v116, v9
  v_and_b32 v146, v116, v10
  v_and_b32 v147, v116, v11
  v_mfma_f32_16x16x32_bf16 v[152:155], v[148:151], a[12:15], v[152:155]
  v_and_b32 v148, v117, v8
  v_and_b32 v149, v117, v9
  v_and_b32 v150, v117, v10
  v_and_b32 v151, v117, v11
  s_waitcnt vmcnt(36)
  v_mfma_f32_16x16x32_bf16 v[152:155], v[144:147], a[16:19], v[152:155]
  v_and_b32 v144, v118, v8
  v_and_b32 v145, v118, v9
  v_and_b32 v146, v118, v10
  v_and_b32 v147, v118, v11
  v_mfma_f32_16x16x32_bf16 v[152:155], v[148:151], a[20:23], v[152:155]
  v_and_b32 v148, v119, v8
  v_and_b32 v149, v119, v9
  v_and_b32 v150, v119, v10
  v_and_b32 v151, v119, v11
  v_mfma_f32_16x16x32_bf16 v[152:155], v[144:147], a[24:27], v[152:155]
  v_and_b32 v144, v120, v8
  v_and_b32 v145, v120, v9
  v_and_b32 v146, v120, v10
  v_and_b32 v147, v120, v11
  v_mfma_f32_16x16x32_bf16 v[152:155], v[148:151], a[28:31], v[152:155]
  v_and_b32 v148, v121, v8
  v_and_b32 v149, v121, v9
  v_and_b32 v150, v121, v10
  v_and_b32 v151, v121, v11
  s_waitcnt vmcnt(28)
  buffer_load_dwordx4 v[180:183], v2, s[28:31], s100 offen offset:0 nt
  buffer_load_dwordx4 v[184:187], v2, s[28:31], s100 offen offset:1024 nt
  buffer_load_dwordx4 v[188:191], v2, s[28:31], s100 offen offset:2048 nt
  buffer_load_dwordx4 v[192:195], v2, s[28:31], s100 offen offset:3072 nt
  v_mfma_f32_16x16x32_bf16 v[152:155], v[144:147], a[32:35], v[152:155]
  v_and_b32 v144, v122, v8
  v_and_b32 v145, v122, v9
  v_and_b32 v146, v122, v10
  v_and_b32 v147, v122, v11
  v_mfma_f32_16x16x32_bf16 v[152:155], v[148:151], a[36:39], v[152:155]
  v_and_b32 v148, v123, v8
  v_and_b32 v149, v123, v9
  v_and_b32 v150, v123, v10
  v_and_b32 v151, v123, v11
  v_mfma_f32_16x16x32_bf16 v[152:155], v[144:147], a[40:43], v[152:155]
  v_and_b32 v144, v124, v8
  v_and_b32 v145, v124, v9
  v_and_b32 v146, v124, v10
  v_and_b32 v147, v124, v11
  v_mfma_f32_16x16x32_bf16 v[152:155], v[148:151], a[44:47], v[152:155]
  v_and_b32 v148, v125, v8
  v_and_b32 v149, v125, v9
  v_and_b32 v150, v125, v10
  v_and_b32 v151, v125, v11
  s_waitcnt vmcnt(28)
  v_mfma_f32_16x16x32_bf16 v[152:155], v[144:147], a[48:51], v[152:155]
  v_and_b32 v144, v126, v8
  v_and_b32 v145, v126, v9
  v_and_b32 v146, v126, v10
  v_and_b32 v147, v126, v11
  v_mfma_f32_16x16x32_bf16 v[152:155], v[148:151], a[52:55], v[152:155]
  v_and_b32 v148, v127, v8
  v_and_b32 v149, v127, v9
  v_and_b32 v150, v127, v10
  v_and_b32 v151, v127, v11
  v_mfma_f32_16x16x32_bf16 v[152:155], v[144:147], a[56:59], v[152:155]
  v_and_b32 v144, v128, v8
  v_and_b32 v145, v128, v9
  v_and_b32 v146, v128, v10
  v_and_b32 v147, v128, v11
  v_mfma_f32_16x16x32_bf16 v[152:155], v[148:151], a[60:63], v[152:155]
  v_and_b32 v148, v129, v8
  v_and_b32 v149, v129, v9
  v_and_b32 v150, v129, v10
  v_and_b32 v151, v129, v11
  s_waitcnt vmcnt(20)
  buffer_load_dwordx4 v[196:199], v2, s[32:35], s100 offen offset:0 nt
  buffer_load_dwordx4 v[200:203], v2, s[32:35], s100 offen offset:1024 nt
  buffer_load_dwordx4 v[204:207], v2, s[32:35], s100 offen offset:2048 nt
  buffer_load_dwordx4 v[208:211], v2, s[32:35], s100 offen offset:3072 nt
  v_mfma_f32_16x16x32_bf16 v[152:155], v[144:147], a[64:67], v[152:155]
  v_and_b32 v144, v130, v8
  v_and_b32 v145, v130, v9
  v_and_b32 v146, v130, v10
  v_and_b32 v147, v130, v11
  v_mfma_f32_16x16x32_bf16 v[152:155], v[148:151], a[68:71], v[152:155]
  v_and_b32 v148, v131, v8
  v_and_b32 v149, v131, v9
  v_and_b32 v150, v131, v10
  v_and_b32 v151, v131, v11
  v_mfma_f32_16x16x32_bf16 v[152:155], v[144:147], a[72:75], v[152:155]
  v_and_b32 v144, v132, v8
  v_and_b32 v145, v132, v9
  v_and_b32 v146, v132, v10
  v_and_b32 v147, v132, v11
  v_mfma_f32_16x16x32_bf16 v[152:155], v[148:151], a[76:79], v[152:155]
  v_and_b32 v148, v133, v8
  v_and_b32 v149, v133, v9
  v_and_b32 v150, v133, v10
  v_and_b32 v151, v133, v11
  s_waitcnt vmcnt(20)
  v_mfma_f32_16x16x32_bf16 v[152:155], v[144:147], a[80:83], v[152:155]
  v_and_b32 v144, v134, v8
  v_and_b32 v145, v134, v9
  v_and_b32 v146, v134, v10
  v_and_b32 v147, v134, v11
  v_mfma_f32_16x16x32_bf16 v[152:155], v[148:151], a[84:87], v[152:155]
  v_and_b32 v148, v135, v8
  v_and_b32 v149, v135, v9
  v_and_b32 v150, v135, v10
  v_and_b32 v151, v135, v11
  v_mfma_f32_16x16x32_bf16 v[152:155], v[144:147], a[88:91], v[152:155]
  v_and_b32 v144, v136, v8
  v_and_b32 v145, v136, v9
  v_and_b32 v146, v136, v10
  v_and_b32 v147, v136, v11
  v_mfma_f32_16x16x32_bf16 v[152:155], v[148:151], a[92:95], v[152:155]
  v_and_b32 v148, v137, v8
  v_and_b32 v149, v137, v9
  v_and_b32 v150, v137, v10
  v_and_b32 v151, v137, v11
  s_waitcnt vmcnt(12)
  buffer_load_dwordx4 v[212:215], v2, s[28:31], s101 offen offset:0 nt
  buffer_load_dwordx4 v[216:219], v2, s[28:31], s101 offen offset:1024 nt
  buffer_load_dwordx4 v[220:223], v2, s[28:31], s101 offen offset:2048 nt
  buffer_load_dwordx4 v[224:227], v2, s[28:31], s101 offen offset:3072 nt
  v_mfma_f32_16x16x32_bf16 v[152:155], v[144:147], a[96:99], v[152:155]
  v_and_b32 v144, v138, v8
  v_and_b32 v145, v138, v9
  v_and_b32 v146, v138, v10
  v_and_b32 v147, v138, v11
  v_mfma_f32_16x16x32_bf16 v[152:155], v[148:151], a[100:103], v[152:155]
  v_and_b32 v148, v139, v8
  v_and_b32 v149, v139, v9
  v_and_b32 v150, v139, v10
  v_and_b32 v151, v139, v11
  v_mfma_f32_16x16x32_bf16 v[152:155], v[144:147], a[104:107], v[152:155]
  v_and_b32 v144, v140, v8
  v_and_b32 v145, v140, v9
  v_and_b32 v146, v140, v10
  v_and_b32 v147, v140, v11
  v_mfma_f32_16x16x32_bf16 v[152:155], v[148:151], a[108:111], v[152:155]
  v_and_b32 v148, v141, v8
  v_and_b32 v149, v141, v9
  v_and_b32 v150, v141, v10
  v_and_b32 v151, v141, v11
  s_waitcnt vmcnt(12)
  buffer_load_dwordx4 v[228:231], v2, s[32:35], s101 offen offset:0 nt
  buffer_load_dwordx4 v[232:235], v2, s[32:35], s101 offen offset:1024 nt
  buffer_load_dwordx4 v[236:239], v2, s[32:35], s101 offen offset:2048 nt
  buffer_load_dwordx4 v[240:243], v2, s[32:35], s101 offen offset:3072 nt
  v_mfma_f32_16x16x32_bf16 v[152:155], v[144:147], a[112:115], v[152:155]
  v_and_b32 v144, v142, v8
  v_and_b32 v145, v142, v9
  v_and_b32 v146, v142, v10
  v_and_b32 v147, v142, v11
  v_mfma_f32_16x16x32_bf16 v[152:155], v[148:151], a[116:119], v[152:155]
  v_and_b32 v148, v143, v8
  v_and_b32 v149, v143, v9
  v_and_b32 v150, v143, v10
  v_and_b32 v151, v143, v11
  v_mfma_f32_16x16x32_bf16 v[152:155], v[144:147], a[120:123], v[152:155]
  s_nop 0
  v_mfma_f32_16x16x32_bf16 v[152:155], v[148:151], a[124:127], v[152:155]
  v_and_b32 v172, 1, v3
  v_lshlrev_b32 v172, 4, v172
  v_lshl_add_u32 v172, v4, 5, v172
  s_lshl_b32 s72, s26, 9
  v_add_u32 v172, s72, v172
  s_nop 2
  ds_write_b128 v172, v[152:155] offset:2304
  v_lshlrev_b32 v173, 5, v4
  s_waitcnt lgkmcnt(0)
  s_barrier
  ds_read_b128 v[112:115], v173 offset:2304
  ds_read_b128 v[116:119], v173 offset:2320
  ds_read_b128 v[120:123], v173 offset:2816
  ds_read_b128 v[124:127], v173 offset:2832
  ds_read_b128 v[128:131], v173 offset:3328
  ds_read_b128 v[132:135], v173 offset:3344
  ds_read_b128 v[136:139], v173 offset:3840
  ds_read_b128 v[140:143], v173 offset:3856
  s_waitcnt lgkmcnt(0)
  v_add_f32 v112, v112, v120
  v_add_f32 v128, v128, v136
  v_add_f32 v113, v113, v121
  v_add_f32 v129, v129, v137
  v_add_f32 v114, v114, v122
  v_add_f32 v130, v130, v138
  v_add_f32 v115, v115, v123
  v_add_f32 v131, v131, v139
  v_add_f32 v116, v116, v124
  v_add_f32 v132, v132, v140
  v_add_f32 v117, v117, v125
  v_add_f32 v133, v133, v141
  v_add_f32 v118, v118, v126
  v_add_f32 v134, v134, v142
  v_add_f32 v119, v119, v127
  v_add_f32 v135, v135, v143
  v_add_f32 v112, v112, v128
  v_add_f32 v113, v113, v129
  v_add_f32 v114, v114, v130
  v_add_f32 v115, v115, v131
  v_add_f32 v116, v116, v132
  v_add_f32 v117, v117, v133
  v_add_f32 v118, v118, v134
  v_add_f32 v119, v119, v135
  v_cvt_pk_bf16_f32 v12, v112, v113
  v_cvt_pk_bf16_f32 v13, v114, v115
  v_cvt_pk_bf16_f32 v14, v116, v117
  v_cvt_pk_bf16_f32 v15, v118, v119
  v_dot2_f32_bf16 v30, v48, v12, 0
  v_dot2_f32_bf16 v31, v52, v12, 0
  v_dot2_f32_bf16 v32, v56, v12, 0
  v_dot2_f32_bf16 v33, v60, v12, 0
  v_dot2_f32_bf16 v30, v49, v13, v30
  v_dot2_f32_bf16 v31, v53, v13, v31
  v_dot2_f32_bf16 v32, v57, v13, v32
  v_dot2_f32_bf16 v33, v61, v13, v33
  v_dot2_f32_bf16 v30, v50, v14, v30
  v_dot2_f32_bf16 v31, v54, v14, v31
  v_dot2_f32_bf16 v32, v58, v14, v32
  v_dot2_f32_bf16 v33, v62, v14, v33
  v_dot2_f32_bf16 v30, v51, v15, v30
  v_dot2_f32_bf16 v31, v55, v15, v31
  v_dot2_f32_bf16 v32, v59, v15, v32
  v_dot2_f32_bf16 v33, v63, v15, v33
  v_add_f32_dpp v34, v30, v30 row_ror:8 row_mask:0xf bank_mask:0x3
  s_nop 0
  v_add_f32_dpp v35, v32, v32 row_ror:8 row_mask:0xf bank_mask:0x3
  v_add_f32_dpp v34, v31, v31 row_ror:8 row_mask:0xf bank_mask:0xc
  s_nop 0
  v_add_f32_dpp v35, v33, v33 row_ror:8 row_mask:0xf bank_mask:0xc
  s_mov_b32 s86, s80
  s_add_u32 s80, s80, 32768
  buffer_load_dwordx4 v[48:51], v2, s[28:31], s86 offen offset:0 nt
  buffer_load_dwordx4 v[52:55], v2, s[28:31], s86 offen offset:1024 nt
  buffer_load_dwordx4 v[56:59], v2, s[28:31], s86 offen offset:2048 nt
  buffer_load_dwordx4 v[60:63], v2, s[28:31], s86 offen offset:3072 nt
  v_add_f32_dpp v36, v34, v34 row_half_mirror row_mask:0xf bank_mask:0x5
  s_nop 1
  v_add_f32_dpp v36, v35, v35 row_half_mirror row_mask:0xf bank_mask:0xa
  s_nop 1
  v_add_f32_dpp v36, v36, v36 quad_perm:[1,0,3,2] row_mask:0xf bank_mask:0xf
  s_nop 1
  v_add_f32_dpp v36, v36, v36 quad_perm:[2,3,0,1] row_mask:0xf bank_mask:0xf
  v_cvt_pk_bf16_f32 v37, v36, v36
  v_and_b32 v37, 0xffff0000, v37
  v_mul_f32 v37, 0x3db504f3, v37
  v_cvt_pk_bf16_f32 v37, v37, v37
  v_and_b32 v37, 0xffff0000, v37
  v_mul_f32 v38, 0x3fb8aa3b, v37
  s_nop 1
  v_max_f32_dpp v39, v38, v38 row_ror:4 row_mask:0xf bank_mask:0xf
  s_nop 1
  v_max_f32_dpp v39, v39, v39 row_ror:8 row_mask:0xf bank_mask:0xf
  v_cmp_gt_f32 vcc, v39, v24
  s_cbranch_vccz L_nors_1
  v_max_f32 v39, v39, v24
  v_sub_f32 v43, v24, v39
  v_exp_f32 v43, v43
  v_mov_b32 v24, v39
  v_mul_f32 v25, v25, v43
  v_mul_f32 v16, v16, v43
  v_mul_f32 v17, v17, v43
  v_mul_f32 v18, v18, v43
  v_mul_f32 v19, v19, v43
  v_mul_f32 v20, v20, v43
  v_mul_f32 v21, v21, v43
  v_mul_f32 v22, v22, v43
  v_mul_f32 v23, v23, v43
L_nors_1:
  v_sub_f32 v40, v38, v24
  v_exp_f32 v40, v40
  s_nop 0
  v_cvt_pk_bf16_f32 v41, v40, 0
  v_add_f32 v25, v25, v40
  v_lshlrev_b32 v42, 16, v41
  v_dot2c_f32_bf16_dpp v16, v41, v64 row_newbcast:0 row_mask:0xf bank_mask:0xf
  v_dot2c_f32_bf16_dpp v18, v41, v65 row_newbcast:0 row_mask:0xf bank_mask:0xf
  v_dot2c_f32_bf16_dpp v20, v41, v66 row_newbcast:0 row_mask:0xf bank_mask:0xf
  v_dot2c_f32_bf16_dpp v22, v41, v67 row_newbcast:0 row_mask:0xf bank_mask:0xf
  v_dot2c_f32_bf16_dpp v17, v42, v64 row_newbcast:0 row_mask:0xf bank_mask:0xf
  v_dot2c_f32_bf16_dpp v19, v42, v65 row_newbcast:0 row_mask:0xf bank_mask:0xf
  v_dot2c_f32_bf16_dpp v21, v42, v66 row_newbcast:0 row_mask:0xf bank_mask:0xf
  v_dot2c_f32_bf16_dpp v23, v42, v67 row_newbcast:0 row_mask:0xf bank_mask:0xf
  v_dot2c_f32_bf16_dpp v16, v41, v68 row_newbcast:8 row_mask:0xf bank_mask:0xf
  v_dot2c_f32_bf16_dpp v18, v41, v69 row_newbcast:8 row_mask:0xf bank_mask:0xf
  v_dot2c_f32_bf16_dpp v20, v41, v70 row_newbcast:8 row_mask:0xf bank_mask:0xf
  v_dot2c_f32_bf16_dpp v22, v41, v71 row_newbcast:8 row_mask:0xf bank_mask:0xf
  v_dot2c_f32_bf16_dpp v17, v42, v68 row_newbcast:8 row_mask:0xf bank_mask:0xf
  v_dot2c_f32_bf16_dpp v19, v42, v69 row_newbcast:8 row_mask:0xf bank_mask:0xf
  v_dot2c_f32_bf16_dpp v21, v42, v70 row_newbcast:8 row_mask:0xf bank_mask:0xf
  v_dot2c_f32_bf16_dpp v23, v42, v71 row_newbcast:8 row_mask:0xf bank_mask:0xf
  v_dot2c_f32_bf16_dpp v16, v41, v72 row_newbcast:4 row_mask:0xf bank_mask:0xf
  v_dot2c_f32_bf16_dpp v18, v41, v73 row_newbcast:4 row_mask:0xf bank_mask:0xf
  v_dot2c_f32_bf16_dpp v20, v41, v74 row_newbcast:4 row_mask:0xf bank_mask:0xf
  v_dot2c_f32_bf16_dpp v22, v41, v75 row_newbcast:4 row_mask:0xf bank_mask:0xf
  v_dot2c_f32_bf16_dpp v17, v42, v72 row_newbcast:4 row_mask:0xf bank_mask:0xf
  v_dot2c_f32_bf16_dpp v19, v42, v73 row_newbcast:4 row_mask:0xf bank_mask:0xf
  v_dot2c_f32_bf16_dpp v21, v42, v74 row_newbcast:4 row_mask:0xf bank_mask:0xf
  v_dot2c_f32_bf16_dpp v23, v42, v75 row_newbcast:4 row_mask:0xf bank_mask:0xf
  v_dot2c_f32_bf16_dpp v16, v41, v76 row_newbcast:12 row_mask:0xf bank_mask:0xf
  v_dot2c_f32_bf16_dpp v18, v41, v77 row_newbcast:12 row_mask:0xf bank_mask:0xf
  v_dot2c_f32_bf16_dpp v20, v41, v78 row_newbcast:12 row_mask:0xf bank_mask:0xf
  v_dot2c_f32_bf16_dpp v22, v41, v79 row_newbcast:12 row_mask:0xf bank_mask:0xf
  v_dot2c_f32_bf16_dpp v17, v42, v76 row_newbcast:12 row_mask:0xf bank_mask:0xf
  v_dot2c_f32_bf16_dpp v19, v42, v77 row_newbcast:12 row_mask:0xf bank_mask:0xf
  v_dot2c_f32_bf16_dpp v21, v42, v78 row_newbcast:12 row_mask:0xf bank_mask:0xf
  v_dot2c_f32_bf16_dpp v23, v42, v79 row_newbcast:12 row_mask:0xf bank_mask:0xf
  buffer_load_dwordx4 v[64:67], v2, s[32:35], s86 offen offset:0 nt
  buffer_load_dwordx4 v[68:71], v2, s[32:35], s86 offen offset:1024 nt
  buffer_load_dwordx4 v[72:75], v2, s[32:35], s86 offen offset:2048 nt
  buffer_load_dwordx4 v[76:79], v2, s[32:35], s86 offen offset:3072 nt
  v_dot2_f32_bf16 v30, v80, v12, 0
  v_dot2_f32_bf16 v31, v84, v12, 0
  v_dot2_f32_bf16 v32, v88, v12, 0
  v_dot2_f32_bf16 v33, v92, v12, 0
  v_dot2_f32_bf16 v30, v81, v13, v30
  v_dot2_f32_bf16 v31, v85, v13, v31
  v_dot2_f32_bf16 v32, v89, v13, v32
  v_dot2_f32_bf16 v33, v93, v13, v33
  v_dot2_f32_bf16 v30, v82, v14, v30
  v_dot2_f32_bf16 v31, v86, v14, v31
  v_dot2_f32_bf16 v32, v90, v14, v32
  v_dot2_f32_bf16 v33, v94, v14, v33
  v_dot2_f32_bf16 v30, v83, v15, v30
  v_dot2_f32_bf16 v31, v87, v15, v31
  v_dot2_f32_bf16 v32, v91, v15, v32
  v_dot2_f32_bf16 v33, v95, v15, v33
  v_add_f32_dpp v34, v30, v30 row_ror:8 row_mask:0xf bank_mask:0x3
  s_nop 0
  v_add_f32_dpp v35, v32, v32 row_ror:8 row_mask:0xf bank_mask:0x3
  v_add_f32_dpp v34, v31, v31 row_ror:8 row_mask:0xf bank_mask:0xc
  s_nop 0
  v_add_f32_dpp v35, v33, v33 row_ror:8 row_mask:0xf bank_mask:0xc
  s_mov_b32 s87, s80
  s_add_u32 s80, s80, 32768
  buffer_load_dwordx4 v[80:83], v2, s[28:31], s87 offen offset:0 nt
  buffer_load_dwordx4 v[84:87], v2, s[28:31], s87 offen offset:1024 nt
  buffer_load_dwordx4 v[88:91], v2, s[28:31], s87 offen offset:2048 nt
  buffer_load_dwordx4 v[92:95], v2, s[28:31], s87 offen offset:3072 nt
  v_add_f32_dpp v36, v34, v34 row_half_mirror row_mask:0xf bank_mask:0x5
  s_nop 1
  v_add_f32_dpp v36, v35, v35 row_half_mirror row_mask:0xf bank_mask:0xa
  s_nop 1
  v_add_f32_dpp v36, v36, v36 quad_perm:[1,0,3,2] row_mask:0xf bank_mask:0xf
  s_nop 1
  v_add_f32_dpp v36, v36, v36 quad_perm:[2,3,0,1] row_mask:0xf bank_mask:0xf
  v_cvt_pk_bf16_f32 v37, v36, v36
  v_and_b32 v37, 0xffff0000, v37
  v_mul_f32 v37, 0x3db504f3, v37
  v_cvt_pk_bf16_f32 v37, v37, v37
  v_and_b32 v37, 0xffff0000, v37
  v_mul_f32 v38, 0x3fb8aa3b, v37
  s_nop 1
  v_max_f32_dpp v39, v38, v38 row_ror:4 row_mask:0xf bank_mask:0xf
  s_nop 1
  v_max_f32_dpp v39, v39, v39 row_ror:8 row_mask:0xf bank_mask:0xf
  v_cmp_gt_f32 vcc, v39, v24
  s_cbranch_vccz L_nors_2
  v_max_f32 v39, v39, v24
  v_sub_f32 v43, v24, v39
  v_exp_f32 v43, v43
  v_mov_b32 v24, v39
  v_mul_f32 v25, v25, v43
  v_mul_f32 v16, v16, v43
  v_mul_f32 v17, v17, v43
  v_mul_f32 v18, v18, v43
  v_mul_f32 v19, v19, v43
  v_mul_f32 v20, v20, v43
  v_mul_f32 v21, v21, v43
  v_mul_f32 v22, v22, v43
  v_mul_f32 v23, v23, v43
L_nors_2:
  v_sub_f32 v40, v38, v24
  v_exp_f32 v40, v40
  s_nop 0
  v_cvt_pk_bf16_f32 v41, v40, 0
  v_add_f32 v25, v25, v40
  v_lshlrev_b32 v42, 16, v41
  v_dot2c_f32_bf16_dpp v16, v41, v96 row_newbcast:0 row_mask:0xf bank_mask:0xf
  v_dot2c_f32_bf16_dpp v18, v41, v97 row_newbcast:0 row_mask:0xf bank_mask:0xf
  v_dot2c_f32_bf16_dpp v20, v41, v98 row_newbcast:0 row_mask:0xf bank_mask:0xf
  v_dot2c_f32_bf16_dpp v22, v41, v99 row_newbcast:0 row_mask:0xf bank_mask:0xf
  v_dot2c_f32_bf16_dpp v17, v42, v96 row_newbcast:0 row_mask:0xf bank_mask:0xf
  v_dot2c_f32_bf16_dpp v19, v42, v97 row_newbcast:0 row_mask:0xf bank_mask:0xf
  v_dot2c_f32_bf16_dpp v21, v42, v98 row_newbcast:0 row_mask:0xf bank_mask:0xf
  v_dot2c_f32_bf16_dpp v23, v42, v99 row_newbcast:0 row_mask:0xf bank_mask:0xf
  v_dot2c_f32_bf16_dpp v16, v41, v100 row_newbcast:8 row_mask:0xf bank_mask:0xf
  v_dot2c_f32_bf16_dpp v18, v41, v101 row_newbcast:8 row_mask:0xf bank_mask:0xf
  v_dot2c_f32_bf16_dpp v20, v41, v102 row_newbcast:8 row_mask:0xf bank_mask:0xf
  v_dot2c_f32_bf16_dpp v22, v41, v103 row_newbcast:8 row_mask:0xf bank_mask:0xf
  v_dot2c_f32_bf16_dpp v17, v42, v100 row_newbcast:8 row_mask:0xf bank_mask:0xf
  v_dot2c_f32_bf16_dpp v19, v42, v101 row_newbcast:8 row_mask:0xf bank_mask:0xf
  v_dot2c_f32_bf16_dpp v21, v42, v102 row_newbcast:8 row_mask:0xf bank_mask:0xf
  v_dot2c_f32_bf16_dpp v23, v42, v103 row_newbcast:8 row_mask:0xf bank_mask:0xf
  v_dot2c_f32_bf16_dpp v16, v41, v104 row_newbcast:4 row_mask:0xf bank_mask:0xf
  v_dot2c_f32_bf16_dpp v18, v41, v105 row_newbcast:4 row_mask:0xf bank_mask:0xf
  v_dot2c_f32_bf16_dpp v20, v41, v106 row_newbcast:4 row_mask:0xf bank_mask:0xf
  v_dot2c_f32_bf16_dpp v22, v41, v107 row_newbcast:4 row_mask:0xf bank_mask:0xf
  v_dot2c_f32_bf16_dpp v17, v42, v104 row_newbcast:4 row_mask:0xf bank_mask:0xf
  v_dot2c_f32_bf16_dpp v19, v42, v105 row_newbcast:4 row_mask:0xf bank_mask:0xf
  v_dot2c_f32_bf16_dpp v21, v42, v106 row_newbcast:4 row_mask:0xf bank_mask:0xf
  v_dot2c_f32_bf16_dpp v23, v42, v107 row_newbcast:4 row_mask:0xf bank_mask:0xf
  v_dot2c_f32_bf16_dpp v16, v41, v108 row_newbcast:12 row_mask:0xf bank_mask:0xf
  v_dot2c_f32_bf16_dpp v18, v41, v109 row_newbcast:12 row_mask:0xf bank_mask:0xf
  v_dot2c_f32_bf16_dpp v20, v41, v110 row_newbcast:12 row_mask:0xf bank_mask:0xf
  v_dot2c_f32_bf16_dpp v22, v41, v111 row_newbcast:12 row_mask:0xf bank_mask:0xf
  v_dot2c_f32_bf16_dpp v17, v42, v108 row_newbcast:12 row_mask:0xf bank_mask:0xf
  v_dot2c_f32_bf16_dpp v19, v42, v109 row_newbcast:12 row_mask:0xf bank_mask:0xf
  v_dot2c_f32_bf16_dpp v21, v42, v110 row_newbcast:12 row_mask:0xf bank_mask:0xf
  v_dot2c_f32_bf16_dpp v23, v42, v111 row_newbcast:12 row_mask:0xf bank_mask:0xf
  buffer_load_dwordx4 v[96:99], v2, s[32:35], s87 offen offset:0 nt
  buffer_load_dwordx4 v[100:103], v2, s[32:35], s87 offen offset:1024 nt
  buffer_load_dwordx4 v[104:107], v2, s[32:35], s87 offen offset:2048 nt
  buffer_load_dwordx4 v[108:111], v2, s[32:35], s87 offen offset:3072 nt
  s_waitcnt vmcnt(28)
  v_dot2_f32_bf16 v30, v180, v12, 0
  v_dot2_f32_bf16 v31, v184, v12, 0
  v_dot2_f32_bf16 v32, v188, v12, 0
  v_dot2_f32_bf16 v33, v192, v12, 0
  v_dot2_f32_bf16 v30, v181, v13, v30
  v_dot2_f32_bf16 v31, v185, v13, v31
  v_dot2_f32_bf16 v32, v189, v13, v32
  v_dot2_f32_bf16 v33, v193, v13, v33
  v_dot2_f32_bf16 v30, v182, v14, v30
  v_dot2_f32_bf16 v31, v186, v14, v31
  v_dot2_f32_bf16 v32, v190, v14, v32
  v_dot2_f32_bf16 v33, v194, v14, v33
  v_dot2_f32_bf16 v30, v183, v15, v30
  v_dot2_f32_bf16 v31, v187, v15, v31
  v_dot2_f32_bf16 v32, v191, v15, v32
  v_dot2_f32_bf16 v33, v195, v15, v33
  v_add_f32_dpp v34, v30, v30 row_ror:8 row_mask:0xf bank_mask:0x3
  s_nop 0
  v_add_f32_dpp v35, v32, v32 row_ror:8 row_mask:0xf bank_mask:0x3
  v_add_f32_dpp v34, v31, v31 row_ror:8 row_mask:0xf bank_mask:0xc
  s_nop 0
  v_add_f32_dpp v35, v33, v33 row_ror:8 row_mask:0xf bank_mask:0xc
  v_add_f32_dpp v36, v34, v34 row_half_mirror row_mask:0xf bank_mask:0x5
  s_nop 1
  v_add_f32_dpp v36, v35, v35 row_half_mirror row_mask:0xf bank_mask:0xa
  s_nop 1
  v_add_f32_dpp v36, v36, v36 quad_perm:[1,0,3,2] row_mask:0xf bank_mask:0xf
  s_nop 1
  v_add_f32_dpp v36, v36, v36 quad_perm:[2,3,0,1] row_mask:0xf bank_mask:0xf
  v_cvt_pk_bf16_f32 v37, v36, v36
  v_and_b32 v37, 0xffff0000, v37
  v_mul_f32 v37, 0x3db504f3, v37
  v_cvt_pk_bf16_f32 v37, v37, v37
  v_and_b32 v37, 0xffff0000, v37
  v_mul_f32 v38, 0x3fb8aa3b, v37
  s_nop 1
  v_max_f32_dpp v39, v38, v38 row_ror:4 row_mask:0xf bank_mask:0xf
  s_nop 1
  v_max_f32_dpp v39, v39, v39 row_ror:8 row_mask:0xf bank_mask:0xf
  v_cmp_gt_f32 vcc, v39, v24
  s_cbranch_vccz L_nors_3
  v_max_f32 v39, v39, v24
  v_sub_f32 v43, v24, v39
  v_exp_f32 v43, v43
  v_mov_b32 v24, v39
  v_mul_f32 v25, v25, v43
  v_mul_f32 v16, v16, v43
  v_mul_f32 v17, v17, v43
  v_mul_f32 v18, v18, v43
  v_mul_f32 v19, v19, v43
  v_mul_f32 v20, v20, v43
  v_mul_f32 v21, v21, v43
  v_mul_f32 v22, v22, v43
  v_mul_f32 v23, v23, v43
L_nors_3:
  v_sub_f32 v40, v38, v24
  v_exp_f32 v40, v40
  s_nop 0
  v_cvt_pk_bf16_f32 v41, v40, 0
  v_add_f32 v25, v25, v40
  v_lshlrev_b32 v42, 16, v41
  s_waitcnt vmcnt(24)
  v_dot2c_f32_bf16_dpp v16, v41, v196 row_newbcast:0 row_mask:0xf bank_mask:0xf
  v_dot2c_f32_bf16_dpp v18, v41, v197 row_newbcast:0 row_mask:0xf bank_mask:0xf
  v_dot2c_f32_bf16_dpp v20, v41, v198 row_newbcast:0 row_mask:0xf bank_mask:0xf
  v_dot2c_f32_bf16_dpp v22, v41, v199 row_newbcast:0 row_mask:0xf bank_mask:0xf
  v_dot2c_f32_bf16_dpp v17, v42, v196 row_newbcast:0 row_mask:0xf bank_mask:0xf
  v_dot2c_f32_bf16_dpp v19, v42, v197 row_newbcast:0 row_mask:0xf bank_mask:0xf
  v_dot2c_f32_bf16_dpp v21, v42, v198 row_newbcast:0 row_mask:0xf bank_mask:0xf
  v_dot2c_f32_bf16_dpp v23, v42, v199 row_newbcast:0 row_mask:0xf bank_mask:0xf
  v_dot2c_f32_bf16_dpp v16, v41, v200 row_newbcast:8 row_mask:0xf bank_mask:0xf
  v_dot2c_f32_bf16_dpp v18, v41, v201 row_newbcast:8 row_mask:0xf bank_mask:0xf
  v_dot2c_f32_bf16_dpp v20, v41, v202 row_newbcast:8 row_mask:0xf bank_mask:0xf
  v_dot2c_f32_bf16_dpp v22, v41, v203 row_newbcast:8 row_mask:0xf bank_mask:0xf
  v_dot2c_f32_bf16_dpp v17, v42, v200 row_newbcast:8 row_mask:0xf bank_mask:0xf
  v_dot2c_f32_bf16_dpp v19, v42, v201 row_newbcast:8 row_mask:0xf bank_mask:0xf
  v_dot2c_f32_bf16_dpp v21, v42, v202 row_newbcast:8 row_mask:0xf bank_mask:0xf
  v_dot2c_f32_bf16_dpp v23, v42, v203 row_newbcast:8 row_mask:0xf bank_mask:0xf
  v_dot2c_f32_bf16_dpp v16, v41, v204 row_newbcast:4 row_mask:0xf bank_mask:0xf
  v_dot2c_f32_bf16_dpp v18, v41, v205 row_newbcast:4 row_mask:0xf bank_mask:0xf
  v_dot2c_f32_bf16_dpp v20, v41, v206 row_newbcast:4 row_mask:0xf bank_mask:0xf
  v_dot2c_f32_bf16_dpp v22, v41, v207 row_newbcast:4 row_mask:0xf bank_mask:0xf
  v_dot2c_f32_bf16_dpp v17, v42, v204 row_newbcast:4 row_mask:0xf bank_mask:0xf
  v_dot2c_f32_bf16_dpp v19, v42, v205 row_newbcast:4 row_mask:0xf bank_mask:0xf
  v_dot2c_f32_bf16_dpp v21, v42, v206 row_newbcast:4 row_mask:0xf bank_mask:0xf
  v_dot2c_f32_bf16_dpp v23, v42, v207 row_newbcast:4 row_mask:0xf bank_mask:0xf
  v_dot2c_f32_bf16_dpp v16, v41, v208 row_newbcast:12 row_mask:0xf bank_mask:0xf
  v_dot2c_f32_bf16_dpp v18, v41, v209 row_newbcast:12 row_mask:0xf bank_mask:0xf
  v_dot2c_f32_bf16_dpp v20, v41, v210 row_newbcast:12 row_mask:0xf bank_mask:0xf
  v_dot2c_f32_bf16_dpp v22, v41, v211 row_newbcast:12 row_mask:0xf bank_mask:0xf
  v_dot2c_f32_bf16_dpp v17, v42, v208 row_newbcast:12 row_mask:0xf bank_mask:0xf
  v_dot2c_f32_bf16_dpp v19, v42, v209 row_newbcast:12 row_mask:0xf bank_mask:0xf
  v_dot2c_f32_bf16_dpp v21, v42, v210 row_newbcast:12 row_mask:0xf bank_mask:0xf
  v_dot2c_f32_bf16_dpp v23, v42, v211 row_newbcast:12 row_mask:0xf bank_mask:0xf
  s_waitcnt vmcnt(20)
  v_dot2_f32_bf16 v30, v212, v12, 0
  v_dot2_f32_bf16 v31, v216, v12, 0
  v_dot2_f32_bf16 v32, v220, v12, 0
  v_dot2_f32_bf16 v33, v224, v12, 0
  v_dot2_f32_bf16 v30, v213, v13, v30
  v_dot2_f32_bf16 v31, v217, v13, v31
  v_dot2_f32_bf16 v32, v221, v13, v32
  v_dot2_f32_bf16 v33, v225, v13, v33
  v_dot2_f32_bf16 v30, v214, v14, v30
  v_dot2_f32_bf16 v31, v218, v14, v31
  v_dot2_f32_bf16 v32, v222, v14, v32
  v_dot2_f32_bf16 v33, v226, v14, v33
  v_dot2_f32_bf16 v30, v215, v15, v30
  v_dot2_f32_bf16 v31, v219, v15, v31
  v_dot2_f32_bf16 v32, v223, v15, v32
  v_dot2_f32_bf16 v33, v227, v15, v33
  v_add_f32_dpp v34, v30, v30 row_ror:8 row_mask:0xf bank_mask:0x3
  s_nop 0
  v_add_f32_dpp v35, v32, v32 row_ror:8 row_mask:0xf bank_mask:0x3
  v_add_f32_dpp v34, v31, v31 row_ror:8 row_mask:0xf bank_mask:0xc
  s_nop 0
  v_add_f32_dpp v35, v33, v33 row_ror:8 row_mask:0xf bank_mask:0xc
  v_add_f32_dpp v36, v34, v34 row_half_mirror row_mask:0xf bank_mask:0x5
  s_nop 1
  v_add_f32_dpp v36, v35, v35 row_half_mirror row_mask:0xf bank_mask:0xa
  s_nop 1
  v_add_f32_dpp v36, v36, v36 quad_perm:[1,0,3,2] row_mask:0xf bank_mask:0xf
  s_nop 1
  v_add_f32_dpp v36, v36, v36 quad_perm:[2,3,0,1] row_mask:0xf bank_mask:0xf
  v_cvt_pk_bf16_f32 v37, v36, v36
  v_and_b32 v37, 0xffff0000, v37
  v_mul_f32 v37, 0x3db504f3, v37
  v_cvt_pk_bf16_f32 v37, v37, v37
  v_and_b32 v37, 0xffff0000, v37
  v_mul_f32 v38, 0x3fb8aa3b, v37
  s_nop 1
  v_max_f32_dpp v39, v38, v38 row_ror:4 row_mask:0xf bank_mask:0xf
  s_nop 1
  v_max_f32_dpp v39, v39, v39 row_ror:8 row_mask:0xf bank_mask:0xf
  v_cmp_gt_f32 vcc, v39, v24
  s_cbranch_vccz L_nors_4
  v_max_f32 v39, v39, v24
  v_sub_f32 v43, v24, v39
  v_exp_f32 v43, v43
  v_mov_b32 v24, v39
  v_mul_f32 v25, v25, v43
  v_mul_f32 v16, v16, v43
  v_mul_f32 v17, v17, v43
  v_mul_f32 v18, v18, v43
  v_mul_f32 v19, v19, v43
  v_mul_f32 v20, v20, v43
  v_mul_f32 v21, v21, v43
  v_mul_f32 v22, v22, v43
  v_mul_f32 v23, v23, v43
L_nors_4:
  v_sub_f32 v40, v38, v24
  v_exp_f32 v40, v40
  s_nop 0
  v_cvt_pk_bf16_f32 v41, v40, 0
  v_add_f32 v25, v25, v40
  v_lshlrev_b32 v42, 16, v41
  s_waitcnt vmcnt(16)
  v_dot2c_f32_bf16_dpp v16, v41, v228 row_newbcast:0 row_mask:0xf bank_mask:0xf
  v_dot2c_f32_bf16_dpp v18, v41, v229 row_newbcast:0 row_mask:0xf bank_mask:0xf
  v_dot2c_f32_bf16_dpp v20, v41, v230 row_newbcast:0 row_mask:0xf bank_mask:0xf
  v_dot2c_f32_bf16_dpp v22, v41, v231 row_newbcast:0 row_mask:0xf bank_mask:0xf
  v_dot2c_f32_bf16_dpp v17, v42, v228 row_newbcast:0 row_mask:0xf bank_mask:0xf
  v_dot2c_f32_bf16_dpp v19, v42, v229 row_newbcast:0 row_mask:0xf bank_mask:0xf
  v_dot2c_f32_bf16_dpp v21, v42, v230 row_newbcast:0 row_mask:0xf bank_mask:0xf
  v_dot2c_f32_bf16_dpp v23, v42, v231 row_newbcast:0 row_mask:0xf bank_mask:0xf
  v_dot2c_f32_bf16_dpp v16, v41, v232 row_newbcast:8 row_mask:0xf bank_mask:0xf
  v_dot2c_f32_bf16_dpp v18, v41, v233 row_newbcast:8 row_mask:0xf bank_mask:0xf
  v_dot2c_f32_bf16_dpp v20, v41, v234 row_newbcast:8 row_mask:0xf bank_mask:0xf
  v_dot2c_f32_bf16_dpp v22, v41, v235 row_newbcast:8 row_mask:0xf bank_mask:0xf
  v_dot2c_f32_bf16_dpp v17, v42, v232 row_newbcast:8 row_mask:0xf bank_mask:0xf
  v_dot2c_f32_bf16_dpp v19, v42, v233 row_newbcast:8 row_mask:0xf bank_mask:0xf
  v_dot2c_f32_bf16_dpp v21, v42, v234 row_newbcast:8 row_mask:0xf bank_mask:0xf
  v_dot2c_f32_bf16_dpp v23, v42, v235 row_newbcast:8 row_mask:0xf bank_mask:0xf
  v_dot2c_f32_bf16_dpp v16, v41, v236 row_newbcast:4 row_mask:0xf bank_mask:0xf
  v_dot2c_f32_bf16_dpp v18, v41, v237 row_newbcast:4 row_mask:0xf bank_mask:0xf
  v_dot2c_f32_bf16_dpp v20, v41, v238 row_newbcast:4 row_mask:0xf bank_mask:0xf
  v_dot2c_f32_bf16_dpp v22, v41, v239 row_newbcast:4 row_mask:0xf bank_mask:0xf
  v_dot2c_f32_bf16_dpp v17, v42, v236 row_newbcast:4 row_mask:0xf bank_mask:0xf
  v_dot2c_f32_bf16_dpp v19, v42, v237 row_newbcast:4 row_mask:0xf bank_mask:0xf
  v_dot2c_f32_bf16_dpp v21, v42, v238 row_newbcast:4 row_mask:0xf bank_mask:0xf
  v_dot2c_f32_bf16_dpp v23, v42, v239 row_newbcast:4 row_mask:0xf bank_mask:0xf
  v_dot2c_f32_bf16_dpp v16, v41, v240 row_newbcast:12 row_mask:0xf bank_mask:0xf
  v_dot2c_f32_bf16_dpp v18, v41, v241 row_newbcast:12 row_mask:0xf bank_mask:0xf
  v_dot2c_f32_bf16_dpp v20, v41, v242 row_newbcast:12 row_mask:0xf bank_mask:0xf
  v_dot2c_f32_bf16_dpp v22, v41, v243 row_newbcast:12 row_mask:0xf bank_mask:0xf
  v_dot2c_f32_bf16_dpp v17, v42, v240 row_newbcast:12 row_mask:0xf bank_mask:0xf
  v_dot2c_f32_bf16_dpp v19, v42, v241 row_newbcast:12 row_mask:0xf bank_mask:0xf
  v_dot2c_f32_bf16_dpp v21, v42, v242 row_newbcast:12 row_mask:0xf bank_mask:0xf
  v_dot2c_f32_bf16_dpp v23, v42, v243 row_newbcast:12 row_mask:0xf bank_mask:0xf
  s_waitcnt vmcnt(12)
  v_dot2_f32_bf16 v30, v48, v12, 0
  v_dot2_f32_bf16 v31, v52, v12, 0
  v_dot2_f32_bf16 v32, v56, v12, 0
  v_dot2_f32_bf16 v33, v60, v12, 0
  v_dot2_f32_bf16 v30, v49, v13, v30
  v_dot2_f32_bf16 v31, v53, v13, v31
  v_dot2_f32_bf16 v32, v57, v13, v32
  v_dot2_f32_bf16 v33, v61, v13, v33
  v_dot2_f32_bf16 v30, v50, v14, v30
  v_dot2_f32_bf16 v31, v54, v14, v31
  v_dot2_f32_bf16 v32, v58, v14, v32
  v_dot2_f32_bf16 v33, v62, v14, v33
  v_dot2_f32_bf16 v30, v51, v15, v30
  v_dot2_f32_bf16 v31, v55, v15, v31
  v_dot2_f32_bf16 v32, v59, v15, v32
  v_dot2_f32_bf16 v33, v63, v15, v33
  v_add_f32_dpp v34, v30, v30 row_ror:8 row_mask:0xf bank_mask:0x3
  s_nop 0
  v_add_f32_dpp v35, v32, v32 row_ror:8 row_mask:0xf bank_mask:0x3
  v_add_f32_dpp v34, v31, v31 row_ror:8 row_mask:0xf bank_mask:0xc
  s_nop 0
  v_add_f32_dpp v35, v33, v33 row_ror:8 row_mask:0xf bank_mask:0xc
  s_cmp_lt_u32 s2, 43
  s_cselect_b32 s71, 1, 0
  s_cselect_b32 s72, 0x170000, 0
  s_mov_b32 s73, 1409024
  s_mov_b32 s40, s24
  s_mov_b32 s41, s25
  s_mov_b32 s42, 0x170000
  s_mov_b32 s43, 0x20000
  s_mov_b32 s60, s24
  s_mov_b32 s61, s25
  s_mov_b32 s62, s72
  s_mov_b32 s63, 0x20000
  s_mov_b32 s44, s16
  s_mov_b32 s45, s17
  s_mov_b32 s46, s73
  s_mov_b32 s47, 0x20000
  s_mov_b32 s48, s18
  s_mov_b32 s49, s19
  s_mov_b32 s50, s73
  s_mov_b32 s51, 0x20000
  s_mov_b32 s56, s20
  s_mov_b32 s57, s21
  s_mov_b32 s58, 0x1000
  s_mov_b32 s59, 0x20000
  s_mov_b32 s64, s22
  s_mov_b32 s65, s23
  s_mov_b32 s66, 0x100
  s_mov_b32 s67, 0x20000
  s_mov_b32 s36, s12
  s_mov_b32 s37, s13
  s_mov_b32 s38, 0x400000
  s_mov_b32 s39, 0x20000
  s_mov_b32 s90, 4096
  v_mov_b32 v28, 1
  v_mov_b32 v160, 0x7ff00000
  v_mov_b32 v180, -1
  v_mov_b32 v181, -1
  v_mov_b32 v182, -1
  v_mov_b32 v183, -1
  s_lshl_b32 s72, s70, 8
  s_add_u32 s72, s72, 0
  v_mov_b32 v29, s72
  s_or_b32 s73, s27, s26
  s_cmp_eq_u32 s73, 0
  s_cselect_b32 s73, s72, 0x7ff00000
  v_mov_b32 v193, s73
  v_cmp_eq_u32 vcc, 0, v1
  s_nop 1
  v_cndmask_b32 v193, v160, v193, vcc
  v_lshlrev_b32 v161, 4, v4
  v_lshl_add_u32 v202, v3, 14, v161
  s_lshl_b32 s72, s26, 6
  s_lshl_b32 s73, s68, 1
  s_add_u32 s72, s72, s73
  s_add_u32 s72, s72, s27
  s_lshl_b32 s72, s72, 11
  s_lshl_b32 s73, s69, 9
  s_add_u32 s72, s72, s73
  s_add_u32 s72, s72, 65536
  v_and_b32 v161, 1, v3
  v_lshlrev_b32 v161, 4, v161
  v_lshl_add_u32 v161, v4, 5, v161
  v_add_u32 v186, s72, v161
  v_cmp_gt_u32 vcc, 32, v1
  s_nop 1
  v_cndmask_b32 v186, v160, v186, vcc
  v_and_b32 v161, 1, v3
  v_lshlrev_b32 v161, 4, v161
  v_lshl_add_u32 v161, v4, 5, v161
  s_lshl_b32 s72, s2, 13
  s_lshl_b32 s73, s26, 9
  s_add_u32 s72, s72, s73
  s_add_u32 s72, s72, 868352
  v_lshrrev_b32 v162, 1, v3
  v_lshl_add_u32 v162, v162, 11, v161
  v_add_u32 v189, s72, v162
  s_mov_b32 s91, 4096
  s_lshl_b32 s74, s68, 2
  s_add_u32 s75, s74, s69
  s_lshl_b32 s75, s75, 1
  s_add_u32 s75, s75, s27
  s_lshl_b32 s72, s75, 10
  s_add_u32 s72, s72, 589824
  v_lshl_add_u32 v194, v0, 3, s72
  v_cmp_gt_u32 vcc, 0x80, v0
  s_nop 1
  v_cndmask_b32 v194, v160, v194, vcc
  v_cmp_eq_u32 vcc, 0, v0
  s_and_b32 s72, s2, 3
  s_lshl_b32 s72, s72, 6
  v_mov_b32 v197, s72
  v_cndmask_b32 v197, v160, v197, vcc
  v_and_b32 v198, 3, v1
  v_lshlrev_b32 v198, 6, v198
  s_add_u32 s74, s74, s26
  s_lshl_b32 s72, s74, 11
  s_lshl_b32 s73, s27, 9
  s_add_u32 s72, s72, s73
  s_add_u32 s72, s72, 589824
  v_lshl_add_u32 v195, v1, 3, s72
  v_add_u32 v187, 1024, v195
  s_cmp_eq_u32 s26, s69
  s_cselect_b32 s72, 1, 0
  s_and_b32 s73, s72, s27
  s_andn2_b32 s72, s72, s27
  s_cmp_lg_u32 s72, 0
  s_cselect_b64 s[96:97], -1, 0
  s_cmp_lg_u32 s73, 0
  s_cselect_b64 s[98:99], -1, 0
  v_cndmask_b32 v195, v195, v160, s[96:97]
  v_cndmask_b32 v187, v187, v160, s[98:99]
  s_lshl_b32 s74, s2, 5
  s_add_u32 s74, s74, 851968
  v_lshrrev_b32 v161, 3, v1
  v_lshl_add_u32 v188, v161, 2, s74
  v_and_b32 v161, 0xc7, v0
  v_cmp_eq_u32 vcc, 0, v161
  s_nop 1
  v_cndmask_b32 v188, v160, v188, vcc
  v_mov_b32 v196, 4
  v_cmp_eq_u32 vcc, 0, v0
  s_nop 1
  v_cndmask_b32 v196, v160, v196, vcc
  v_lshrrev_b32 v161, 2, v1
  v_mul_u32_u24 v161, 2752, v161
  v_and_b32 v162, 3, v1
  v_lshl_add_u32 v7, v162, 4, v161
  buffer_store_dwordx4 v[180:183], v186, s[40:43], 0 offen sc1
  buffer_store_dwordx2 v[180:181], v194, s[40:43], 0 offen sc1
  buffer_store_dword v180, v188, s[40:43], 0 offen sc1
  buffer_store_dwordx4 v[180:183], v189, s[60:63], 0 offen sc1
  buffer_store_dwordx4 v[180:183], v189, s[60:63], s91 offen sc1
  buffer_store_dword v46, v193, s[40:43], 0 offen sc1
  v_add_f32_dpp v36, v34, v34 row_half_mirror row_mask:0xf bank_mask:0x5
  s_nop 1
  v_add_f32_dpp v36, v35, v35 row_half_mirror row_mask:0xf bank_mask:0xa
  s_nop 1
  v_add_f32_dpp v36, v36, v36 quad_perm:[1,0,3,2] row_mask:0xf bank_mask:0xf
  s_nop 1
  v_add_f32_dpp v36, v36, v36 quad_perm:[2,3,0,1] row_mask:0xf bank_mask:0xf
  v_cvt_pk_bf16_f32 v37, v36, v36
  v_and_b32 v37, 0xffff0000, v37
  v_mul_f32 v37, 0x3db504f3, v37
  v_cvt_pk_bf16_f32 v37, v37, v37
  v_and_b32 v37, 0xffff0000, v37
  v_mul_f32 v38, 0x3fb8aa3b, v37
  s_nop 1
  v_max_f32_dpp v39, v38, v38 row_ror:4 row_mask:0xf bank_mask:0xf
  s_nop 1
  v_max_f32_dpp v39, v39, v39 row_ror:8 row_mask:0xf bank_mask:0xf
  v_cmp_gt_f32 vcc, v39, v24
  s_cbranch_vccz L_nors_5
  v_max_f32 v39, v39, v24
  v_sub_f32 v43, v24, v39
  v_exp_f32 v43, v43
  v_mov_b32 v24, v39
  v_mul_f32 v25, v25, v43
  v_mul_f32 v16, v16, v43
  v_mul_f32 v17, v17, v43
  v_mul_f32 v18, v18, v43
  v_mul_f32 v19, v19, v43
  v_mul_f32 v20, v20, v43
  v_mul_f32 v21, v21, v43
  v_mul_f32 v22, v22, v43
  v_mul_f32 v23, v23, v43
L_nors_5:
  v_sub_f32 v40, v38, v24
  v_exp_f32 v40, v40
  s_nop 0
  v_cvt_pk_bf16_f32 v41, v40, 0
  v_add_f32 v25, v25, v40
  v_lshlrev_b32 v42, 16, v41
  s_waitcnt vmcnt(14)
  v_dot2c_f32_bf16_dpp v16, v41, v64 row_newbcast:0 row_mask:0xf bank_mask:0xf
  v_dot2c_f32_bf16_dpp v18, v41, v65 row_newbcast:0 row_mask:0xf bank_mask:0xf
  v_dot2c_f32_bf16_dpp v20, v41, v66 row_newbcast:0 row_mask:0xf bank_mask:0xf
  v_dot2c_f32_bf16_dpp v22, v41, v67 row_newbcast:0 row_mask:0xf bank_mask:0xf
  v_dot2c_f32_bf16_dpp v17, v42, v64 row_newbcast:0 row_mask:0xf bank_mask:0xf
  v_dot2c_f32_bf16_dpp v19, v42, v65 row_newbcast:0 row_mask:0xf bank_mask:0xf
  v_dot2c_f32_bf16_dpp v21, v42, v66 row_newbcast:0 row_mask:0xf bank_mask:0xf
  v_dot2c_f32_bf16_dpp v23, v42, v67 row_newbcast:0 row_mask:0xf bank_mask:0xf
  v_dot2c_f32_bf16_dpp v16, v41, v68 row_newbcast:8 row_mask:0xf bank_mask:0xf
  v_dot2c_f32_bf16_dpp v18, v41, v69 row_newbcast:8 row_mask:0xf bank_mask:0xf
  v_dot2c_f32_bf16_dpp v20, v41, v70 row_newbcast:8 row_mask:0xf bank_mask:0xf
  v_dot2c_f32_bf16_dpp v22, v41, v71 row_newbcast:8 row_mask:0xf bank_mask:0xf
  v_dot2c_f32_bf16_dpp v17, v42, v68 row_newbcast:8 row_mask:0xf bank_mask:0xf
  v_dot2c_f32_bf16_dpp v19, v42, v69 row_newbcast:8 row_mask:0xf bank_mask:0xf
  v_dot2c_f32_bf16_dpp v21, v42, v70 row_newbcast:8 row_mask:0xf bank_mask:0xf
  v_dot2c_f32_bf16_dpp v23, v42, v71 row_newbcast:8 row_mask:0xf bank_mask:0xf
  v_dot2c_f32_bf16_dpp v16, v41, v72 row_newbcast:4 row_mask:0xf bank_mask:0xf
  v_dot2c_f32_bf16_dpp v18, v41, v73 row_newbcast:4 row_mask:0xf bank_mask:0xf
  v_dot2c_f32_bf16_dpp v20, v41, v74 row_newbcast:4 row_mask:0xf bank_mask:0xf
  v_dot2c_f32_bf16_dpp v22, v41, v75 row_newbcast:4 row_mask:0xf bank_mask:0xf
  v_dot2c_f32_bf16_dpp v17, v42, v72 row_newbcast:4 row_mask:0xf bank_mask:0xf
  v_dot2c_f32_bf16_dpp v19, v42, v73 row_newbcast:4 row_mask:0xf bank_mask:0xf
  v_dot2c_f32_bf16_dpp v21, v42, v74 row_newbcast:4 row_mask:0xf bank_mask:0xf
  v_dot2c_f32_bf16_dpp v23, v42, v75 row_newbcast:4 row_mask:0xf bank_mask:0xf
  v_dot2c_f32_bf16_dpp v16, v41, v76 row_newbcast:12 row_mask:0xf bank_mask:0xf
  v_dot2c_f32_bf16_dpp v18, v41, v77 row_newbcast:12 row_mask:0xf bank_mask:0xf
  v_dot2c_f32_bf16_dpp v20, v41, v78 row_newbcast:12 row_mask:0xf bank_mask:0xf
  v_dot2c_f32_bf16_dpp v22, v41, v79 row_newbcast:12 row_mask:0xf bank_mask:0xf
  v_dot2c_f32_bf16_dpp v17, v42, v76 row_newbcast:12 row_mask:0xf bank_mask:0xf
  v_dot2c_f32_bf16_dpp v19, v42, v77 row_newbcast:12 row_mask:0xf bank_mask:0xf
  v_dot2c_f32_bf16_dpp v21, v42, v78 row_newbcast:12 row_mask:0xf bank_mask:0xf
  v_dot2c_f32_bf16_dpp v23, v42, v79 row_newbcast:12 row_mask:0xf bank_mask:0xf
  s_waitcnt vmcnt(10)
  v_dot2_f32_bf16 v30, v80, v12, 0
  v_dot2_f32_bf16 v31, v84, v12, 0
  v_dot2_f32_bf16 v32, v88, v12, 0
  v_dot2_f32_bf16 v33, v92, v12, 0
  v_dot2_f32_bf16 v30, v81, v13, v30
  v_dot2_f32_bf16 v31, v85, v13, v31
  v_dot2_f32_bf16 v32, v89, v13, v32
  v_dot2_f32_bf16 v33, v93, v13, v33
  v_dot2_f32_bf16 v30, v82, v14, v30
  v_dot2_f32_bf16 v31, v86, v14, v31
  v_dot2_f32_bf16 v32, v90, v14, v32
  v_dot2_f32_bf16 v33, v94, v14, v33
  v_dot2_f32_bf16 v30, v83, v15, v30
  v_dot2_f32_bf16 v31, v87, v15, v31
  v_dot2_f32_bf16 v32, v91, v15, v32
  v_dot2_f32_bf16 v33, v95, v15, v33
  v_add_f32_dpp v34, v30, v30 row_ror:8 row_mask:0xf bank_mask:0x3
  s_nop 0
  v_add_f32_dpp v35, v32, v32 row_ror:8 row_mask:0xf bank_mask:0x3
  v_add_f32_dpp v34, v31, v31 row_ror:8 row_mask:0xf bank_mask:0xc
  s_nop 0
  v_add_f32_dpp v35, v33, v33 row_ror:8 row_mask:0xf bank_mask:0xc
  s_mov_b32 s86, s80
  s_add_u32 s80, s80, 32768
  buffer_load_dwordx4 v[48:51], v2, s[28:31], s86 offen offset:0 nt
  buffer_load_dwordx4 v[52:55], v2, s[28:31], s86 offen offset:1024 nt
  buffer_load_dwordx4 v[56:59], v2, s[28:31], s86 offen offset:2048 nt
  buffer_load_dwordx4 v[60:63], v2, s[28:31], s86 offen offset:3072 nt
  s_lshl_b32 s77, s68, 17
  s_lshl_b32 s78, s27, 16
  s_add_u32 s77, s77, s78
  s_lshl_b32 s78, s69, 8
  s_add_u32 s77, s77, s78
  s_lshl_b32 s78, s26, 12
  s_add_u32 s77, s77, s78
  s_lshl_b32 s79, s26, 12
  s_add_u32 s79, s79, 49152
  s_mov_b32 m0, s79
  s_add_u32 s79, s79, 1024
  buffer_load_dwordx4 v202, s[36:39], s77 offen nt lds
  s_add_u32 s77, s77, 1024
  s_mov_b32 m0, s79
  s_add_u32 s79, s79, 1024
  buffer_load_dwordx4 v202, s[36:39], s77 offen nt lds
  s_add_u32 s77, s77, 1024
  s_mov_b32 m0, s79
  s_add_u32 s79, s79, 1024
  buffer_load_dwordx4 v202, s[36:39], s77 offen nt lds
  s_add_u32 s77, s77, 1024
  s_mov_b32 m0, s79
  s_add_u32 s79, s79, 1024
  buffer_load_dwordx4 v202, s[36:39], s77 offen nt lds
  s_add_u32 s77, s77, 1024
  v_add_f32_dpp v36, v34, v34 row_half_mirror row_mask:0xf bank_mask:0x5
  s_nop 1
  v_add_f32_dpp v36, v35, v35 row_half_mirror row_mask:0xf bank_mask:0xa
  s_nop 1
  v_add_f32_dpp v36, v36, v36 quad_perm:[1,0,3,2] row_mask:0xf bank_mask:0xf
  s_nop 1
  v_add_f32_dpp v36, v36, v36 quad_perm:[2,3,0,1] row_mask:0xf bank_mask:0xf
  v_cvt_pk_bf16_f32 v37, v36, v36
  v_and_b32 v37, 0xffff0000, v37
  v_mul_f32 v37, 0x3db504f3, v37
  v_cvt_pk_bf16_f32 v37, v37, v37
  v_and_b32 v37, 0xffff0000, v37
  v_mul_f32 v38, 0x3fb8aa3b, v37
  s_nop 1
  v_max_f32_dpp v39, v38, v38 row_ror:4 row_mask:0xf bank_mask:0xf
  s_nop 1
  v_max_f32_dpp v39, v39, v39 row_ror:8 row_mask:0xf bank_mask:0xf
  v_cmp_gt_f32 vcc, v39, v24
  s_cbranch_vccz L_nors_6
  v_max_f32 v39, v39, v24
  v_sub_f32 v43, v24, v39
  v_exp_f32 v43, v43
  v_mov_b32 v24, v39
  v_mul_f32 v25, v25, v43
  v_mul_f32 v16, v16, v43
  v_mul_f32 v17, v17, v43
  v_mul_f32 v18, v18, v43
  v_mul_f32 v19, v19, v43
  v_mul_f32 v20, v20, v43
  v_mul_f32 v21, v21, v43
  v_mul_f32 v22, v22, v43
  v_mul_f32 v23, v23, v43
L_nors_6:
  v_sub_f32 v40, v38, v24
  v_exp_f32 v40, v40
  s_nop 0
  v_cvt_pk_bf16_f32 v41, v40, 0
  v_add_f32 v25, v25, v40
  v_lshlrev_b32 v42, 16, v41
  s_waitcnt vmcnt(14)
  v_dot2c_f32_bf16_dpp v16, v41, v96 row_newbcast:0 row_mask:0xf bank_mask:0xf
  v_dot2c_f32_bf16_dpp v18, v41, v97 row_newbcast:0 row_mask:0xf bank_mask:0xf
  v_dot2c_f32_bf16_dpp v20, v41, v98 row_newbcast:0 row_mask:0xf bank_mask:0xf
  v_dot2c_f32_bf16_dpp v22, v41, v99 row_newbcast:0 row_mask:0xf bank_mask:0xf
  v_dot2c_f32_bf16_dpp v17, v42, v96 row_newbcast:0 row_mask:0xf bank_mask:0xf
  v_dot2c_f32_bf16_dpp v19, v42, v97 row_newbcast:0 row_mask:0xf bank_mask:0xf
  v_dot2c_f32_bf16_dpp v21, v42, v98 row_newbcast:0 row_mask:0xf bank_mask:0xf
  v_dot2c_f32_bf16_dpp v23, v42, v99 row_newbcast:0 row_mask:0xf bank_mask:0xf
  v_dot2c_f32_bf16_dpp v16, v41, v100 row_newbcast:8 row_mask:0xf bank_mask:0xf
  v_dot2c_f32_bf16_dpp v18, v41, v101 row_newbcast:8 row_mask:0xf bank_mask:0xf
  v_dot2c_f32_bf16_dpp v20, v41, v102 row_newbcast:8 row_mask:0xf bank_mask:0xf
  v_dot2c_f32_bf16_dpp v22, v41, v103 row_newbcast:8 row_mask:0xf bank_mask:0xf
  v_dot2c_f32_bf16_dpp v17, v42, v100 row_newbcast:8 row_mask:0xf bank_mask:0xf
  v_dot2c_f32_bf16_dpp v19, v42, v101 row_newbcast:8 row_mask:0xf bank_mask:0xf
  v_dot2c_f32_bf16_dpp v21, v42, v102 row_newbcast:8 row_mask:0xf bank_mask:0xf
  v_dot2c_f32_bf16_dpp v23, v42, v103 row_newbcast:8 row_mask:0xf bank_mask:0xf
  v_dot2c_f32_bf16_dpp v16, v41, v104 row_newbcast:4 row_mask:0xf bank_mask:0xf
  v_dot2c_f32_bf16_dpp v18, v41, v105 row_newbcast:4 row_mask:0xf bank_mask:0xf
  v_dot2c_f32_bf16_dpp v20, v41, v106 row_newbcast:4 row_mask:0xf bank_mask:0xf
  v_dot2c_f32_bf16_dpp v22, v41, v107 row_newbcast:4 row_mask:0xf bank_mask:0xf
  v_dot2c_f32_bf16_dpp v17, v42, v104 row_newbcast:4 row_mask:0xf bank_mask:0xf
  v_dot2c_f32_bf16_dpp v19, v42, v105 row_newbcast:4 row_mask:0xf bank_mask:0xf
  v_dot2c_f32_bf16_dpp v21, v42, v106 row_newbcast:4 row_mask:0xf bank_mask:0xf
  v_dot2c_f32_bf16_dpp v23, v42, v107 row_newbcast:4 row_mask:0xf bank_mask:0xf
  v_dot2c_f32_bf16_dpp v16, v41, v108 row_newbcast:12 row_mask:0xf bank_mask:0xf
  v_dot2c_f32_bf16_dpp v18, v41, v109 row_newbcast:12 row_mask:0xf bank_mask:0xf
  v_dot2c_f32_bf16_dpp v20, v41, v110 row_newbcast:12 row_mask:0xf bank_mask:0xf
  v_dot2c_f32_bf16_dpp v22, v41, v111 row_newbcast:12 row_mask:0xf bank_mask:0xf
  v_dot2c_f32_bf16_dpp v17, v42, v108 row_newbcast:12 row_mask:0xf bank_mask:0xf
  v_dot2c_f32_bf16_dpp v19, v42, v109 row_newbcast:12 row_mask:0xf bank_mask:0xf
  v_dot2c_f32_bf16_dpp v21, v42, v110 row_newbcast:12 row_mask:0xf bank_mask:0xf
  v_dot2c_f32_bf16_dpp v23, v42, v111 row_newbcast:12 row_mask:0xf bank_mask:0xf
  buffer_load_dwordx4 v[64:67], v2, s[32:35], s86 offen offset:0 nt
  buffer_load_dwordx4 v[68:71], v2, s[32:35], s86 offen offset:1024 nt
  buffer_load_dwordx4 v[72:75], v2, s[32:35], s86 offen offset:2048 nt
  buffer_load_dwordx4 v[76:79], v2, s[32:35], s86 offen offset:3072 nt
  s_waitcnt vmcnt(8)
  v_dot2_f32_bf16 v30, v48, v12, 0
  v_dot2_f32_bf16 v31, v52, v12, 0
  v_dot2_f32_bf16 v32, v56, v12, 0
  v_dot2_f32_bf16 v33, v60, v12, 0
  v_dot2_f32_bf16 v30, v49, v13, v30
  v_dot2_f32_bf16 v31, v53, v13, v31
  v_dot2_f32_bf16 v32, v57, v13, v32
  v_dot2_f32_bf16 v33, v61, v13, v33
  v_dot2_f32_bf16 v30, v50, v14, v30
  v_dot2_f32_bf16 v31, v54, v14, v31
  v_dot2_f32_bf16 v32, v58, v14, v32
  v_dot2_f32_bf16 v33, v62, v14, v33
  v_dot2_f32_bf16 v30, v51, v15, v30
  v_dot2_f32_bf16 v31, v55, v15, v31
  v_dot2_f32_bf16 v32, v59, v15, v32
  v_dot2_f32_bf16 v33, v63, v15, v33
  v_add_f32_dpp v34, v30, v30 row_ror:8 row_mask:0xf bank_mask:0x3
  s_nop 0
  v_add_f32_dpp v35, v32, v32 row_ror:8 row_mask:0xf bank_mask:0x3
  v_add_f32_dpp v34, v31, v31 row_ror:8 row_mask:0xf bank_mask:0xc
  s_nop 0
  v_add_f32_dpp v35, v33, v33 row_ror:8 row_mask:0xf bank_mask:0xc
  s_mov_b32 s87, s80
  s_add_u32 s80, s80, 32768
  buffer_load_dwordx4 v[80:83], v2, s[28:31], s87 offen offset:0 nt
  buffer_load_dwordx4 v[84:87], v2, s[28:31], s87 offen offset:1024 nt
  buffer_load_dwordx4 v[88:91], v2, s[28:31], s87 offen offset:2048 nt
  buffer_load_dwordx4 v[92:95], v2, s[28:31], s87 offen offset:3072 nt
  s_barrier
  buffer_atomic_add v28, v197, s[64:67], 0 offen sc1
  v_add_f32_dpp v36, v34, v34 row_half_mirror row_mask:0xf bank_mask:0x5
  s_nop 1
  v_add_f32_dpp v36, v35, v35 row_half_mirror row_mask:0xf bank_mask:0xa
  s_nop 1
  v_add_f32_dpp v36, v36, v36 quad_perm:[1,0,3,2] row_mask:0xf bank_mask:0xf
  s_nop 1
  v_add_f32_dpp v36, v36, v36 quad_perm:[2,3,0,1] row_mask:0xf bank_mask:0xf
  v_cvt_pk_bf16_f32 v37, v36, v36
  v_and_b32 v37, 0xffff0000, v37
  v_mul_f32 v37, 0x3db504f3, v37
  v_cvt_pk_bf16_f32 v37, v37, v37
  v_and_b32 v37, 0xffff0000, v37
  v_mul_f32 v38, 0x3fb8aa3b, v37
  s_nop 1
  v_max_f32_dpp v39, v38, v38 row_ror:4 row_mask:0xf bank_mask:0xf
  s_nop 1
  v_max_f32_dpp v39, v39, v39 row_ror:8 row_mask:0xf bank_mask:0xf
  v_cmp_gt_f32 vcc, v39, v24
  s_cbranch_vccz L_nors_7
  v_max_f32 v39, v39, v24
  v_sub_f32 v43, v24, v39
  v_exp_f32 v43, v43
  v_mov_b32 v24, v39
  v_mul_f32 v25, v25, v43
  v_mul_f32 v16, v16, v43
  v_mul_f32 v17, v17, v43
  v_mul_f32 v18, v18, v43
  v_mul_f32 v19, v19, v43
  v_mul_f32 v20, v20, v43
  v_mul_f32 v21, v21, v43
  v_mul_f32 v22, v22, v43
  v_mul_f32 v23, v23, v43
L_nors_7:
  v_sub_f32 v40, v38, v24
  v_exp_f32 v40, v40
  s_nop 0
  v_cvt_pk_bf16_f32 v41, v40, 0
  v_add_f32 v25, v25, v40
  v_lshlrev_b32 v42, 16, v41
  s_waitcnt vmcnt(5)
  v_dot2c_f32_bf16_dpp v16, v41, v64 row_newbcast:0 row_mask:0xf bank_mask:0xf
  v_dot2c_f32_bf16_dpp v18, v41, v65 row_newbcast:0 row_mask:0xf bank_mask:0xf
  v_dot2c_f32_bf16_dpp v20, v41, v66 row_newbcast:0 row_mask:0xf bank_mask:0xf
  v_dot2c_f32_bf16_dpp v22, v41, v67 row_newbcast:0 row_mask:0xf bank_mask:0xf
  v_dot2c_f32_bf16_dpp v17, v42, v64 row_newbcast:0 row_mask:0xf bank_mask:0xf
  v_dot2c_f32_bf16_dpp v19, v42, v65 row_newbcast:0 row_mask:0xf bank_mask:0xf
  v_dot2c_f32_bf16_dpp v21, v42, v66 row_newbcast:0 row_mask:0xf bank_mask:0xf
  v_dot2c_f32_bf16_dpp v23, v42, v67 row_newbcast:0 row_mask:0xf bank_mask:0xf
  v_dot2c_f32_bf16_dpp v16, v41, v68 row_newbcast:8 row_mask:0xf bank_mask:0xf
  v_dot2c_f32_bf16_dpp v18, v41, v69 row_newbcast:8 row_mask:0xf bank_mask:0xf
  v_dot2c_f32_bf16_dpp v20, v41, v70 row_newbcast:8 row_mask:0xf bank_mask:0xf
  v_dot2c_f32_bf16_dpp v22, v41, v71 row_newbcast:8 row_mask:0xf bank_mask:0xf
  v_dot2c_f32_bf16_dpp v17, v42, v68 row_newbcast:8 row_mask:0xf bank_mask:0xf
  v_dot2c_f32_bf16_dpp v19, v42, v69 row_newbcast:8 row_mask:0xf bank_mask:0xf
  v_dot2c_f32_bf16_dpp v21, v42, v70 row_newbcast:8 row_mask:0xf bank_mask:0xf
  v_dot2c_f32_bf16_dpp v23, v42, v71 row_newbcast:8 row_mask:0xf bank_mask:0xf
  v_dot2c_f32_bf16_dpp v16, v41, v72 row_newbcast:4 row_mask:0xf bank_mask:0xf
  v_dot2c_f32_bf16_dpp v18, v41, v73 row_newbcast:4 row_mask:0xf bank_mask:0xf
  v_dot2c_f32_bf16_dpp v20, v41, v74 row_newbcast:4 row_mask:0xf bank_mask:0xf
  v_dot2c_f32_bf16_dpp v22, v41, v75 row_newbcast:4 row_mask:0xf bank_mask:0xf
  v_dot2c_f32_bf16_dpp v17, v42, v72 row_newbcast:4 row_mask:0xf bank_mask:0xf
  v_dot2c_f32_bf16_dpp v19, v42, v73 row_newbcast:4 row_mask:0xf bank_mask:0xf
  v_dot2c_f32_bf16_dpp v21, v42, v74 row_newbcast:4 row_mask:0xf bank_mask:0xf
  v_dot2c_f32_bf16_dpp v23, v42, v75 row_newbcast:4 row_mask:0xf bank_mask:0xf
  v_dot2c_f32_bf16_dpp v16, v41, v76 row_newbcast:12 row_mask:0xf bank_mask:0xf
  v_dot2c_f32_bf16_dpp v18, v41, v77 row_newbcast:12 row_mask:0xf bank_mask:0xf
  v_dot2c_f32_bf16_dpp v20, v41, v78 row_newbcast:12 row_mask:0xf bank_mask:0xf
  v_dot2c_f32_bf16_dpp v22, v41, v79 row_newbcast:12 row_mask:0xf bank_mask:0xf
  v_dot2c_f32_bf16_dpp v17, v42, v76 row_newbcast:12 row_mask:0xf bank_mask:0xf
  v_dot2c_f32_bf16_dpp v19, v42, v77 row_newbcast:12 row_mask:0xf bank_mask:0xf
  v_dot2c_f32_bf16_dpp v21, v42, v78 row_newbcast:12 row_mask:0xf bank_mask:0xf
  v_dot2c_f32_bf16_dpp v23, v42, v79 row_newbcast:12 row_mask:0xf bank_mask:0xf
  buffer_load_dwordx4 v[96:99], v2, s[32:35], s87 offen offset:0 nt
  buffer_load_dwordx4 v[100:103], v2, s[32:35], s87 offen offset:1024 nt
  buffer_load_dwordx4 v[104:107], v2, s[32:35], s87 offen offset:2048 nt
  buffer_load_dwordx4 v[108:111], v2, s[32:35], s87 offen offset:3072 nt
  s_waitcnt vmcnt(5)
  v_dot2_f32_bf16 v30, v80, v12, 0
  v_dot2_f32_bf16 v31, v84, v12, 0
  v_dot2_f32_bf16 v32, v88, v12, 0
  v_dot2_f32_bf16 v33, v92, v12, 0
  v_dot2_f32_bf16 v30, v81, v13, v30
  v_dot2_f32_bf16 v31, v85, v13, v31
  v_dot2_f32_bf16 v32, v89, v13, v32
  v_dot2_f32_bf16 v33, v93, v13, v33
  v_dot2_f32_bf16 v30, v82, v14, v30
  v_dot2_f32_bf16 v31, v86, v14, v31
  v_dot2_f32_bf16 v32, v90, v14, v32
  v_dot2_f32_bf16 v33, v94, v14, v33
  v_dot2_f32_bf16 v30, v83, v15, v30
  v_dot2_f32_bf16 v31, v87, v15, v31
  v_dot2_f32_bf16 v32, v91, v15, v32
  v_dot2_f32_bf16 v33, v95, v15, v33
  v_add_f32_dpp v34, v30, v30 row_ror:8 row_mask:0xf bank_mask:0x3
  s_nop 0
  v_add_f32_dpp v35, v32, v32 row_ror:8 row_mask:0xf bank_mask:0x3
  v_add_f32_dpp v34, v31, v31 row_ror:8 row_mask:0xf bank_mask:0xc
  s_nop 0
  v_add_f32_dpp v35, v33, v33 row_ror:8 row_mask:0xf bank_mask:0xc
  s_mov_b32 s86, s80
  s_add_u32 s80, s80, 32768
  buffer_load_dwordx4 v[48:51], v2, s[28:31], s86 offen offset:0 nt
  buffer_load_dwordx4 v[52:55], v2, s[28:31], s86 offen offset:1024 nt
  buffer_load_dwordx4 v[56:59], v2, s[28:31], s86 offen offset:2048 nt
  buffer_load_dwordx4 v[60:63], v2, s[28:31], s86 offen offset:3072 nt
  s_getpc_b64 s[88:89]
L_pc_8:
  s_add_u32 s88, s88, L_after_peel-L_pc_8
  s_addc_u32 s89, s89, 0
  v_lshlrev_b32 v45, 6, v0
  v_min_u32 v200, L_code_end-L_after_peel-4, v45
  global_load_dword v254, v200, s[88:89]
  v_add_u32 v45, 16384, v45
  v_min_u32 v200, L_code_end-L_after_peel-4, v45
  global_load_dword v254, v200, s[88:89]
  v_add_f32_dpp v36, v34, v34 row_half_mirror row_mask:0xf bank_mask:0x5
  s_nop 1
  v_add_f32_dpp v36, v35, v35 row_half_mirror row_mask:0xf bank_mask:0xa
  s_nop 1
  v_add_f32_dpp v36, v36, v36 quad_perm:[1,0,3,2] row_mask:0xf bank_mask:0xf
  s_nop 1
  v_add_f32_dpp v36, v36, v36 quad_perm:[2,3,0,1] row_mask:0xf bank_mask:0xf
  v_cvt_pk_bf16_f32 v37, v36, v36
  v_and_b32 v37, 0xffff0000, v37
  v_mul_f32 v37, 0x3db504f3, v37
  v_cvt_pk_bf16_f32 v37, v37, v37
  v_and_b32 v37, 0xffff0000, v37
  v_mul_f32 v38, 0x3fb8aa3b, v37
  s_nop 1
  v_max_f32_dpp v39, v38, v38 row_ror:4 row_mask:0xf bank_mask:0xf
  s_nop 1
  v_max_f32_dpp v39, v39, v39 row_ror:8 row_mask:0xf bank_mask:0xf
  v_cmp_gt_f32 vcc, v39, v24
  s_cbranch_vccz L_nors_9
  v_max_f32 v39, v39, v24
  v_sub_f32 v43, v24, v39
  v_exp_f32 v43, v43
  v_mov_b32 v24, v39
  v_mul_f32 v25, v25, v43
  v_mul_f32 v16, v16, v43
  v_mul_f32 v17, v17, v43
  v_mul_f32 v18, v18, v43
  v_mul_f32 v19, v19, v43
  v_mul_f32 v20, v20, v43
  v_mul_f32 v21, v21, v43
  v_mul_f32 v22, v22, v43
  v_mul_f32 v23, v23, v43
L_nors_9:
  v_sub_f32 v40, v38, v24
  v_exp_f32 v40, v40
  s_nop 0
  v_cvt_pk_bf16_f32 v41, v40, 0
  v_add_f32 v25, v25, v40
  v_lshlrev_b32 v42, 16, v41
  s_waitcnt vmcnt(6)
  v_dot2c_f32_bf16_dpp v16, v41, v96 row_newbcast:0 row_mask:0xf bank_mask:0xf
  v_dot2c_f32_bf16_dpp v18, v41, v97 row_newbcast:0 row_mask:0xf bank_mask:0xf
  v_dot2c_f32_bf16_dpp v20, v41, v98 row_newbcast:0 row_mask:0xf bank_mask:0xf
  v_dot2c_f32_bf16_dpp v22, v41, v99 row_newbcast:0 row_mask:0xf bank_mask:0xf
  v_dot2c_f32_bf16_dpp v17, v42, v96 row_newbcast:0 row_mask:0xf bank_mask:0xf
  v_dot2c_f32_bf16_dpp v19, v42, v97 row_newbcast:0 row_mask:0xf bank_mask:0xf
  v_dot2c_f32_bf16_dpp v21, v42, v98 row_newbcast:0 row_mask:0xf bank_mask:0xf
  v_dot2c_f32_bf16_dpp v23, v42, v99 row_newbcast:0 row_mask:0xf bank_mask:0xf
  v_dot2c_f32_bf16_dpp v16, v41, v100 row_newbcast:8 row_mask:0xf bank_mask:0xf
  v_dot2c_f32_bf16_dpp v18, v41, v101 row_newbcast:8 row_mask:0xf bank_mask:0xf
  v_dot2c_f32_bf16_dpp v20, v41, v102 row_newbcast:8 row_mask:0xf bank_mask:0xf
  v_dot2c_f32_bf16_dpp v22, v41, v103 row_newbcast:8 row_mask:0xf bank_mask:0xf
  v_dot2c_f32_bf16_dpp v17, v42, v100 row_newbcast:8 row_mask:0xf bank_mask:0xf
  v_dot2c_f32_bf16_dpp v19, v42, v101 row_newbcast:8 row_mask:0xf bank_mask:0xf
  v_dot2c_f32_bf16_dpp v21, v42, v102 row_newbcast:8 row_mask:0xf bank_mask:0xf
  v_dot2c_f32_bf16_dpp v23, v42, v103 row_newbcast:8 row_mask:0xf bank_mask:0xf
  v_dot2c_f32_bf16_dpp v16, v41, v104 row_newbcast:4 row_mask:0xf bank_mask:0xf
  v_dot2c_f32_bf16_dpp v18, v41, v105 row_newbcast:4 row_mask:0xf bank_mask:0xf
  v_dot2c_f32_bf16_dpp v20, v41, v106 row_newbcast:4 row_mask:0xf bank_mask:0xf
  v_dot2c_f32_bf16_dpp v22, v41, v107 row_newbcast:4 row_mask:0xf bank_mask:0xf
  v_dot2c_f32_bf16_dpp v17, v42, v104 row_newbcast:4 row_mask:0xf bank_mask:0xf
  v_dot2c_f32_bf16_dpp v19, v42, v105 row_newbcast:4 row_mask:0xf bank_mask:0xf
  v_dot2c_f32_bf16_dpp v21, v42, v106 row_newbcast:4 row_mask:0xf bank_mask:0xf
  v_dot2c_f32_bf16_dpp v23, v42, v107 row_newbcast:4 row_mask:0xf bank_mask:0xf
  v_dot2c_f32_bf16_dpp v16, v41, v108 row_newbcast:12 row_mask:0xf bank_mask:0xf
  v_dot2c_f32_bf16_dpp v18, v41, v109 row_newbcast:12 row_mask:0xf bank_mask:0xf
  v_dot2c_f32_bf16_dpp v20, v41, v110 row_newbcast:12 row_mask:0xf bank_mask:0xf
  v_dot2c_f32_bf16_dpp v22, v41, v111 row_newbcast:12 row_mask:0xf bank_mask:0xf
  v_dot2c_f32_bf16_dpp v17, v42, v108 row_newbcast:12 row_mask:0xf bank_mask:0xf
  v_dot2c_f32_bf16_dpp v19, v42, v109 row_newbcast:12 row_mask:0xf bank_mask:0xf
  v_dot2c_f32_bf16_dpp v21, v42, v110 row_newbcast:12 row_mask:0xf bank_mask:0xf
  v_dot2c_f32_bf16_dpp v23, v42, v111 row_newbcast:12 row_mask:0xf bank_mask:0xf
  buffer_load_dwordx4 v[64:67], v2, s[32:35], s86 offen offset:0 nt
  buffer_load_dwordx4 v[68:71], v2, s[32:35], s86 offen offset:1024 nt
  buffer_load_dwordx4 v[72:75], v2, s[32:35], s86 offen offset:2048 nt
  buffer_load_dwordx4 v[76:79], v2, s[32:35], s86 offen offset:3072 nt
  s_waitcnt vmcnt(6)
  v_dot2_f32_bf16 v30, v48, v12, 0
  v_dot2_f32_bf16 v31, v52, v12, 0
  v_dot2_f32_bf16 v32, v56, v12, 0
  v_dot2_f32_bf16 v33, v60, v12, 0
  v_dot2_f32_bf16 v30, v49, v13, v30
  v_dot2_f32_bf16 v31, v53, v13, v31
  v_dot2_f32_bf16 v32, v57, v13, v32
  v_dot2_f32_bf16 v33, v61, v13, v33
  v_dot2_f32_bf16 v30, v50, v14, v30
  v_dot2_f32_bf16 v31, v54, v14, v31
  v_dot2_f32_bf16 v32, v58, v14, v32
  v_dot2_f32_bf16 v33, v62, v14, v33
  v_dot2_f32_bf16 v30, v51, v15, v30
  v_dot2_f32_bf16 v31, v55, v15, v31
  v_dot2_f32_bf16 v32, v59, v15, v32
  v_dot2_f32_bf16 v33, v63, v15, v33
  v_add_f32_dpp v34, v30, v30 row_ror:8 row_mask:0xf bank_mask:0x3
  s_nop 0
  v_add_f32_dpp v35, v32, v32 row_ror:8 row_mask:0xf bank_mask:0x3
  v_add_f32_dpp v34, v31, v31 row_ror:8 row_mask:0xf bank_mask:0xc
  s_nop 0
  v_add_f32_dpp v35, v33, v33 row_ror:8 row_mask:0xf bank_mask:0xc
  s_mov_b32 s87, s80
  s_add_u32 s80, s80, 32768
  buffer_load_dwordx4 v[80:83], v2, s[28:31], s87 offen offset:0 nt
  buffer_load_dwordx4 v[84:87], v2, s[28:31], s87 offen offset:1024 nt
  buffer_load_dwordx4 v[88:91], v2, s[28:31], s87 offen offset:2048 nt
  buffer_load_dwordx4 v[92:95], v2, s[28:31], s87 offen offset:3072 nt
  v_add_f32_dpp v36, v34, v34 row_half_mirror row_mask:0xf bank_mask:0x5
  s_nop 1
  v_add_f32_dpp v36, v35, v35 row_half_mirror row_mask:0xf bank_mask:0xa
  s_nop 1
  v_add_f32_dpp v36, v36, v36 quad_perm:[1,0,3,2] row_mask:0xf bank_mask:0xf
  s_nop 1
  v_add_f32_dpp v36, v36, v36 quad_perm:[2,3,0,1] row_mask:0xf bank_mask:0xf
  v_cvt_pk_bf16_f32 v37, v36, v36
  v_and_b32 v37, 0xffff0000, v37
  v_mul_f32 v37, 0x3db504f3, v37
  v_cvt_pk_bf16_f32 v37, v37, v37
  v_and_b32 v37, 0xffff0000, v37
  v_mul_f32 v38, 0x3fb8aa3b, v37
  s_nop 1
  v_max_f32_dpp v39, v38, v38 row_ror:4 row_mask:0xf bank_mask:0xf
  s_nop 1
  v_max_f32_dpp v39, v39, v39 row_ror:8 row_mask:0xf bank_mask:0xf
  v_cmp_gt_f32 vcc, v39, v24
  s_cbranch_vccz L_nors_10
  v_max_f32 v39, v39, v24
  v_sub_f32 v43, v24, v39
  v_exp_f32 v43, v43
  v_mov_b32 v24, v39
  v_mul_f32 v25, v25, v43
  v_mul_f32 v16, v16, v43
  v_mul_f32 v17, v17, v43
  v_mul_f32 v18, v18, v43
  v_mul_f32 v19, v19, v43
  v_mul_f32 v20, v20, v43
  v_mul_f32 v21, v21, v43
  v_mul_f32 v22, v22, v43
  v_mul_f32 v23, v23, v43
L_nors_10:
  v_sub_f32 v40, v38, v24
  v_exp_f32 v40, v40
  s_nop 0
  v_cvt_pk_bf16_f32 v41, v40, 0
  v_add_f32 v25, v25, v40
  v_lshlrev_b32 v42, 16, v41
  s_waitcnt vmcnt(4)
  v_dot2c_f32_bf16_dpp v16, v41, v64 row_newbcast:0 row_mask:0xf bank_mask:0xf
  v_dot2c_f32_bf16_dpp v18, v41, v65 row_newbcast:0 row_mask:0xf bank_mask:0xf
  v_dot2c_f32_bf16_dpp v20, v41, v66 row_newbcast:0 row_mask:0xf bank_mask:0xf
  v_dot2c_f32_bf16_dpp v22, v41, v67 row_newbcast:0 row_mask:0xf bank_mask:0xf
  v_dot2c_f32_bf16_dpp v17, v42, v64 row_newbcast:0 row_mask:0xf bank_mask:0xf
  v_dot2c_f32_bf16_dpp v19, v42, v65 row_newbcast:0 row_mask:0xf bank_mask:0xf
  v_dot2c_f32_bf16_dpp v21, v42, v66 row_newbcast:0 row_mask:0xf bank_mask:0xf
  v_dot2c_f32_bf16_dpp v23, v42, v67 row_newbcast:0 row_mask:0xf bank_mask:0xf
  v_dot2c_f32_bf16_dpp v16, v41, v68 row_newbcast:8 row_mask:0xf bank_mask:0xf
  v_dot2c_f32_bf16_dpp v18, v41, v69 row_newbcast:8 row_mask:0xf bank_mask:0xf
  v_dot2c_f32_bf16_dpp v20, v41, v70 row_newbcast:8 row_mask:0xf bank_mask:0xf
  v_dot2c_f32_bf16_dpp v22, v41, v71 row_newbcast:8 row_mask:0xf bank_mask:0xf
  v_dot2c_f32_bf16_dpp v17, v42, v68 row_newbcast:8 row_mask:0xf bank_mask:0xf
  v_dot2c_f32_bf16_dpp v19, v42, v69 row_newbcast:8 row_mask:0xf bank_mask:0xf
  v_dot2c_f32_bf16_dpp v21, v42, v70 row_newbcast:8 row_mask:0xf bank_mask:0xf
  v_dot2c_f32_bf16_dpp v23, v42, v71 row_newbcast:8 row_mask:0xf bank_mask:0xf
  v_dot2c_f32_bf16_dpp v16, v41, v72 row_newbcast:4 row_mask:0xf bank_mask:0xf
  v_dot2c_f32_bf16_dpp v18, v41, v73 row_newbcast:4 row_mask:0xf bank_mask:0xf
  v_dot2c_f32_bf16_dpp v20, v41, v74 row_newbcast:4 row_mask:0xf bank_mask:0xf
  v_dot2c_f32_bf16_dpp v22, v41, v75 row_newbcast:4 row_mask:0xf bank_mask:0xf
  v_dot2c_f32_bf16_dpp v17, v42, v72 row_newbcast:4 row_mask:0xf bank_mask:0xf
  v_dot2c_f32_bf16_dpp v19, v42, v73 row_newbcast:4 row_mask:0xf bank_mask:0xf
  v_dot2c_f32_bf16_dpp v21, v42, v74 row_newbcast:4 row_mask:0xf bank_mask:0xf
  v_dot2c_f32_bf16_dpp v23, v42, v75 row_newbcast:4 row_mask:0xf bank_mask:0xf
  v_dot2c_f32_bf16_dpp v16, v41, v76 row_newbcast:12 row_mask:0xf bank_mask:0xf
  v_dot2c_f32_bf16_dpp v18, v41, v77 row_newbcast:12 row_mask:0xf bank_mask:0xf
  v_dot2c_f32_bf16_dpp v20, v41, v78 row_newbcast:12 row_mask:0xf bank_mask:0xf
  v_dot2c_f32_bf16_dpp v22, v41, v79 row_newbcast:12 row_mask:0xf bank_mask:0xf
  v_dot2c_f32_bf16_dpp v17, v42, v76 row_newbcast:12 row_mask:0xf bank_mask:0xf
  v_dot2c_f32_bf16_dpp v19, v42, v77 row_newbcast:12 row_mask:0xf bank_mask:0xf
  v_dot2c_f32_bf16_dpp v21, v42, v78 row_newbcast:12 row_mask:0xf bank_mask:0xf
  v_dot2c_f32_bf16_dpp v23, v42, v79 row_newbcast:12 row_mask:0xf bank_mask:0xf
  buffer_load_dwordx4 v[96:99], v2, s[32:35], s87 offen offset:0 nt
  buffer_load_dwordx4 v[100:103], v2, s[32:35], s87 offen offset:1024 nt
  buffer_load_dwordx4 v[104:107], v2, s[32:35], s87 offen offset:2048 nt
  buffer_load_dwordx4 v[108:111], v2, s[32:35], s87 offen offset:3072 nt
  s_waitcnt vmcnt(4)
  v_dot2_f32_bf16 v30, v80, v12, 0
  v_dot2_f32_bf16 v31, v84, v12, 0
  v_dot2_f32_bf16 v32, v88, v12, 0
  v_dot2_f32_bf16 v33, v92, v12, 0
  v_dot2_f32_bf16 v30, v81, v13, v30
  v_dot2_f32_bf16 v31, v85, v13, v31
  v_dot2_f32_bf16 v32, v89, v13, v32
  v_dot2_f32_bf16 v33, v93, v13, v33
  v_dot2_f32_bf16 v30, v82, v14, v30
  v_dot2_f32_bf16 v31, v86, v14, v31
  v_dot2_f32_bf16 v32, v90, v14, v32
  v_dot2_f32_bf16 v33, v94, v14, v33
  v_dot2_f32_bf16 v30, v83, v15, v30
  v_dot2_f32_bf16 v31, v87, v15, v31
  v_dot2_f32_bf16 v32, v91, v15, v32
  v_dot2_f32_bf16 v33, v95, v15, v33
  v_add_f32_dpp v34, v30, v30 row_ror:8 row_mask:0xf bank_mask:0x3
  s_nop 0
  v_add_f32_dpp v35, v32, v32 row_ror:8 row_mask:0xf bank_mask:0x3
  v_add_f32_dpp v34, v31, v31 row_ror:8 row_mask:0xf bank_mask:0xc
  s_nop 0
  v_add_f32_dpp v35, v33, v33 row_ror:8 row_mask:0xf bank_mask:0xc
  s_mov_b32 s86, s80
  s_add_u32 s80, s80, 32768
  buffer_load_dwordx4 v[48:51], v2, s[28:31], s86 offen offset:0 nt
  buffer_load_dwordx4 v[52:55], v2, s[28:31], s86 offen offset:1024 nt
  buffer_load_dwordx4 v[56:59], v2, s[28:31], s86 offen offset:2048 nt
  buffer_load_dwordx4 v[60:63], v2, s[28:31], s86 offen offset:3072 nt
  v_add_f32_dpp v36, v34, v34 row_half_mirror row_mask:0xf bank_mask:0x5
  s_nop 1
  v_add_f32_dpp v36, v35, v35 row_half_mirror row_mask:0xf bank_mask:0xa
  s_nop 1
  v_add_f32_dpp v36, v36, v36 quad_perm:[1,0,3,2] row_mask:0xf bank_mask:0xf
  s_nop 1
  v_add_f32_dpp v36, v36, v36 quad_perm:[2,3,0,1] row_mask:0xf bank_mask:0xf
  v_cvt_pk_bf16_f32 v37, v36, v36
  v_and_b32 v37, 0xffff0000, v37
  v_mul_f32 v37, 0x3db504f3, v37
  v_cvt_pk_bf16_f32 v37, v37, v37
  v_and_b32 v37, 0xffff0000, v37
  v_mul_f32 v38, 0x3fb8aa3b, v37
  s_nop 1
  v_max_f32_dpp v39, v38, v38 row_ror:4 row_mask:0xf bank_mask:0xf
  s_nop 1
  v_max_f32_dpp v39, v39, v39 row_ror:8 row_mask:0xf bank_mask:0xf
  v_cmp_gt_f32 vcc, v39, v24
  s_cbranch_vccz L_nors_11
  v_max_f32 v39, v39, v24
  v_sub_f32 v43, v24, v39
  v_exp_f32 v43, v43
  v_mov_b32 v24, v39
  v_mul_f32 v25, v25, v43
  v_mul_f32 v16, v16, v43
  v_mul_f32 v17, v17, v43
  v_mul_f32 v18, v18, v43
  v_mul_f32 v19, v19, v43
  v_mul_f32 v20, v20, v43
  v_mul_f32 v21, v21, v43
  v_mul_f32 v22, v22, v43
  v_mul_f32 v23, v23, v43
L_nors_11:
  v_sub_f32 v40, v38, v24
  v_exp_f32 v40, v40
  s_nop 0
  v_cvt_pk_bf16_f32 v41, v40, 0
  v_add_f32 v25, v25, v40
  v_lshlrev_b32 v42, 16, v41
  s_waitcnt vmcnt(4)
  v_dot2c_f32_bf16_dpp v16, v41, v96 row_newbcast:0 row_mask:0xf bank_mask:0xf
  v_dot2c_f32_bf16_dpp v18, v41, v97 row_newbcast:0 row_mask:0xf bank_mask:0xf
  v_dot2c_f32_bf16_dpp v20, v41, v98 row_newbcast:0 row_mask:0xf bank_mask:0xf
  v_dot2c_f32_bf16_dpp v22, v41, v99 row_newbcast:0 row_mask:0xf bank_mask:0xf
  v_dot2c_f32_bf16_dpp v17, v42, v96 row_newbcast:0 row_mask:0xf bank_mask:0xf
  v_dot2c_f32_bf16_dpp v19, v42, v97 row_newbcast:0 row_mask:0xf bank_mask:0xf
  v_dot2c_f32_bf16_dpp v21, v42, v98 row_newbcast:0 row_mask:0xf bank_mask:0xf
  v_dot2c_f32_bf16_dpp v23, v42, v99 row_newbcast:0 row_mask:0xf bank_mask:0xf
  v_dot2c_f32_bf16_dpp v16, v41, v100 row_newbcast:8 row_mask:0xf bank_mask:0xf
  v_dot2c_f32_bf16_dpp v18, v41, v101 row_newbcast:8 row_mask:0xf bank_mask:0xf
  v_dot2c_f32_bf16_dpp v20, v41, v102 row_newbcast:8 row_mask:0xf bank_mask:0xf
  v_dot2c_f32_bf16_dpp v22, v41, v103 row_newbcast:8 row_mask:0xf bank_mask:0xf
  v_dot2c_f32_bf16_dpp v17, v42, v100 row_newbcast:8 row_mask:0xf bank_mask:0xf
  v_dot2c_f32_bf16_dpp v19, v42, v101 row_newbcast:8 row_mask:0xf bank_mask:0xf
  v_dot2c_f32_bf16_dpp v21, v42, v102 row_newbcast:8 row_mask:0xf bank_mask:0xf
  v_dot2c_f32_bf16_dpp v23, v42, v103 row_newbcast:8 row_mask:0xf bank_mask:0xf
  v_dot2c_f32_bf16_dpp v16, v41, v104 row_newbcast:4 row_mask:0xf bank_mask:0xf
  v_dot2c_f32_bf16_dpp v18, v41, v105 row_newbcast:4 row_mask:0xf bank_mask:0xf
  v_dot2c_f32_bf16_dpp v20, v41, v106 row_newbcast:4 row_mask:0xf bank_mask:0xf
  v_dot2c_f32_bf16_dpp v22, v41, v107 row_newbcast:4 row_mask:0xf bank_mask:0xf
  v_dot2c_f32_bf16_dpp v17, v42, v104 row_newbcast:4 row_mask:0xf bank_mask:0xf
  v_dot2c_f32_bf16_dpp v19, v42, v105 row_newbcast:4 row_mask:0xf bank_mask:0xf
  v_dot2c_f32_bf16_dpp v21, v42, v106 row_newbcast:4 row_mask:0xf bank_mask:0xf
  v_dot2c_f32_bf16_dpp v23, v42, v107 row_newbcast:4 row_mask:0xf bank_mask:0xf
  v_dot2c_f32_bf16_dpp v16, v41, v108 row_newbcast:12 row_mask:0xf bank_mask:0xf
  v_dot2c_f32_bf16_dpp v18, v41, v109 row_newbcast:12 row_mask:0xf bank_mask:0xf
  v_dot2c_f32_bf16_dpp v20, v41, v110 row_newbcast:12 row_mask:0xf bank_mask:0xf
  v_dot2c_f32_bf16_dpp v22, v41, v111 row_newbcast:12 row_mask:0xf bank_mask:0xf
  v_dot2c_f32_bf16_dpp v17, v42, v108 row_newbcast:12 row_mask:0xf bank_mask:0xf
  v_dot2c_f32_bf16_dpp v19, v42, v109 row_newbcast:12 row_mask:0xf bank_mask:0xf
  v_dot2c_f32_bf16_dpp v21, v42, v110 row_newbcast:12 row_mask:0xf bank_mask:0xf
  v_dot2c_f32_bf16_dpp v23, v42, v111 row_newbcast:12 row_mask:0xf bank_mask:0xf
  buffer_load_dwordx4 v[64:67], v2, s[32:35], s86 offen offset:0 nt
  buffer_load_dwordx4 v[68:71], v2, s[32:35], s86 offen offset:1024 nt
  buffer_load_dwordx4 v[72:75], v2, s[32:35], s86 offen offset:2048 nt
  buffer_load_dwordx4 v[76:79], v2, s[32:35], s86 offen offset:3072 nt
  s_waitcnt vmcnt(4)
  v_dot2_f32_bf16 v30, v48, v12, 0
  v_dot2_f32_bf16 v31, v52, v12, 0
  v_dot2_f32_bf16 v32, v56, v12, 0
  v_dot2_f32_bf16 v33, v60, v12, 0
  v_dot2_f32_bf16 v30, v49, v13, v30
  v_dot2_f32_bf16 v31, v53, v13, v31
  v_dot2_f32_bf16 v32, v57, v13, v32
  v_dot2_f32_bf16 v33, v61, v13, v33
  v_dot2_f32_bf16 v30, v50, v14, v30
  v_dot2_f32_bf16 v31, v54, v14, v31
  v_dot2_f32_bf16 v32, v58, v14, v32
  v_dot2_f32_bf16 v33, v62, v14, v33
  v_dot2_f32_bf16 v30, v51, v15, v30
  v_dot2_f32_bf16 v31, v55, v15, v31
  v_dot2_f32_bf16 v32, v59, v15, v32
  v_dot2_f32_bf16 v33, v63, v15, v33
  v_add_f32_dpp v34, v30, v30 row_ror:8 row_mask:0xf bank_mask:0x3
  s_nop 0
  v_add_f32_dpp v35, v32, v32 row_ror:8 row_mask:0xf bank_mask:0x3
  v_add_f32_dpp v34, v31, v31 row_ror:8 row_mask:0xf bank_mask:0xc
  s_nop 0
  v_add_f32_dpp v35, v33, v33 row_ror:8 row_mask:0xf bank_mask:0xc
  s_mov_b32 s87, s80
  s_add_u32 s80, s80, 32768
  buffer_load_dwordx4 v[80:83], v2, s[28:31], s87 offen offset:0 nt
  buffer_load_dwordx4 v[84:87], v2, s[28:31], s87 offen offset:1024 nt
  buffer_load_dwordx4 v[88:91], v2, s[28:31], s87 offen offset:2048 nt
  buffer_load_dwordx4 v[92:95], v2, s[28:31], s87 offen offset:3072 nt
  buffer_load_dword v44, v198, s[64:67], 0 offen sc1
  v_add_f32_dpp v36, v34, v34 row_half_mirror row_mask:0xf bank_mask:0x5
  s_nop 1
  v_add_f32_dpp v36, v35, v35 row_half_mirror row_mask:0xf bank_mask:0xa
  s_nop 1
  v_add_f32_dpp v36, v36, v36 quad_perm:[1,0,3,2] row_mask:0xf bank_mask:0xf
  s_nop 1
  v_add_f32_dpp v36, v36, v36 quad_perm:[2,3,0,1] row_mask:0xf bank_mask:0xf
  v_cvt_pk_bf16_f32 v37, v36, v36
  v_and_b32 v37, 0xffff0000, v37
  v_mul_f32 v37, 0x3db504f3, v37
  v_cvt_pk_bf16_f32 v37, v37, v37
  v_and_b32 v37, 0xffff0000, v37
  v_mul_f32 v38, 0x3fb8aa3b, v37
  s_nop 1
  v_max_f32_dpp v39, v38, v38 row_ror:4 row_mask:0xf bank_mask:0xf
  s_nop 1
  v_max_f32_dpp v39, v39, v39 row_ror:8 row_mask:0xf bank_mask:0xf
  v_cmp_gt_f32 vcc, v39, v24
  s_cbranch_vccz L_nors_12
  v_max_f32 v39, v39, v24
  v_sub_f32 v43, v24, v39
  v_exp_f32 v43, v43
  v_mov_b32 v24, v39
  v_mul_f32 v25, v25, v43
  v_mul_f32 v16, v16, v43
  v_mul_f32 v17, v17, v43
  v_mul_f32 v18, v18, v43
  v_mul_f32 v19, v19, v43
  v_mul_f32 v20, v20, v43
  v_mul_f32 v21, v21, v43
  v_mul_f32 v22, v22, v43
  v_mul_f32 v23, v23, v43
L_nors_12:
  v_sub_f32 v40, v38, v24
  v_exp_f32 v40, v40
  s_nop 0
  v_cvt_pk_bf16_f32 v41, v40, 0
  v_add_f32 v25, v25, v40
  v_lshlrev_b32 v42, 16, v41
  s_waitcnt vmcnt(5)
  v_dot2c_f32_bf16_dpp v16, v41, v64 row_newbcast:0 row_mask:0xf bank_mask:0xf
  v_dot2c_f32_bf16_dpp v18, v41, v65 row_newbcast:0 row_mask:0xf bank_mask:0xf
  v_dot2c_f32_bf16_dpp v20, v41, v66 row_newbcast:0 row_mask:0xf bank_mask:0xf
  v_dot2c_f32_bf16_dpp v22, v41, v67 row_newbcast:0 row_mask:0xf bank_mask:0xf
  v_dot2c_f32_bf16_dpp v17, v42, v64 row_newbcast:0 row_mask:0xf bank_mask:0xf
  v_dot2c_f32_bf16_dpp v19, v42, v65 row_newbcast:0 row_mask:0xf bank_mask:0xf
  v_dot2c_f32_bf16_dpp v21, v42, v66 row_newbcast:0 row_mask:0xf bank_mask:0xf
  v_dot2c_f32_bf16_dpp v23, v42, v67 row_newbcast:0 row_mask:0xf bank_mask:0xf
  v_dot2c_f32_bf16_dpp v16, v41, v68 row_newbcast:8 row_mask:0xf bank_mask:0xf
  v_dot2c_f32_bf16_dpp v18, v41, v69 row_newbcast:8 row_mask:0xf bank_mask:0xf
  v_dot2c_f32_bf16_dpp v20, v41, v70 row_newbcast:8 row_mask:0xf bank_mask:0xf
  v_dot2c_f32_bf16_dpp v22, v41, v71 row_newbcast:8 row_mask:0xf bank_mask:0xf
  v_dot2c_f32_bf16_dpp v17, v42, v68 row_newbcast:8 row_mask:0xf bank_mask:0xf
  v_dot2c_f32_bf16_dpp v19, v42, v69 row_newbcast:8 row_mask:0xf bank_mask:0xf
  v_dot2c_f32_bf16_dpp v21, v42, v70 row_newbcast:8 row_mask:0xf bank_mask:0xf
  v_dot2c_f32_bf16_dpp v23, v42, v71 row_newbcast:8 row_mask:0xf bank_mask:0xf
  v_dot2c_f32_bf16_dpp v16, v41, v72 row_newbcast:4 row_mask:0xf bank_mask:0xf
  v_dot2c_f32_bf16_dpp v18, v41, v73 row_newbcast:4 row_mask:0xf bank_mask:0xf
  v_dot2c_f32_bf16_dpp v20, v41, v74 row_newbcast:4 row_mask:0xf bank_mask:0xf
  v_dot2c_f32_bf16_dpp v22, v41, v75 row_newbcast:4 row_mask:0xf bank_mask:0xf
  v_dot2c_f32_bf16_dpp v17, v42, v72 row_newbcast:4 row_mask:0xf bank_mask:0xf
  v_dot2c_f32_bf16_dpp v19, v42, v73 row_newbcast:4 row_mask:0xf bank_mask:0xf
  v_dot2c_f32_bf16_dpp v21, v42, v74 row_newbcast:4 row_mask:0xf bank_mask:0xf
  v_dot2c_f32_bf16_dpp v23, v42, v75 row_newbcast:4 row_mask:0xf bank_mask:0xf
  v_dot2c_f32_bf16_dpp v16, v41, v76 row_newbcast:12 row_mask:0xf bank_mask:0xf
  v_dot2c_f32_bf16_dpp v18, v41, v77 row_newbcast:12 row_mask:0xf bank_mask:0xf
  v_dot2c_f32_bf16_dpp v20, v41, v78 row_newbcast:12 row_mask:0xf bank_mask:0xf
  v_dot2c_f32_bf16_dpp v22, v41, v79 row_newbcast:12 row_mask:0xf bank_mask:0xf
  v_dot2c_f32_bf16_dpp v17, v42, v76 row_newbcast:12 row_mask:0xf bank_mask:0xf
  v_dot2c_f32_bf16_dpp v19, v42, v77 row_newbcast:12 row_mask:0xf bank_mask:0xf
  v_dot2c_f32_bf16_dpp v21, v42, v78 row_newbcast:12 row_mask:0xf bank_mask:0xf
  v_dot2c_f32_bf16_dpp v23, v42, v79 row_newbcast:12 row_mask:0xf bank_mask:0xf
  buffer_load_dwordx4 v[96:99], v2, s[32:35], s87 offen offset:0 nt
  buffer_load_dwordx4 v[100:103], v2, s[32:35], s87 offen offset:1024 nt
  buffer_load_dwordx4 v[104:107], v2, s[32:35], s87 offen offset:2048 nt
  buffer_load_dwordx4 v[108:111], v2, s[32:35], s87 offen offset:3072 nt
  s_waitcnt vmcnt(5)
  v_dot2_f32_bf16 v30, v80, v12, 0
  v_dot2_f32_bf16 v31, v84, v12, 0
  v_dot2_f32_bf16 v32, v88, v12, 0
  v_dot2_f32_bf16 v33, v92, v12, 0
  v_dot2_f32_bf16 v30, v81, v13, v30
  v_dot2_f32_bf16 v31, v85, v13, v31
  v_dot2_f32_bf16 v32, v89, v13, v32
  v_dot2_f32_bf16 v33, v93, v13, v33
  v_dot2_f32_bf16 v30, v82, v14, v30
  v_dot2_f32_bf16 v31, v86, v14, v31
  v_dot2_f32_bf16 v32, v90, v14, v32
  v_dot2_f32_bf16 v33, v94, v14, v33
  v_dot2_f32_bf16 v30, v83, v15, v30
  v_dot2_f32_bf16 v31, v87, v15, v31
  v_dot2_f32_bf16 v32, v91, v15, v32
  v_dot2_f32_bf16 v33, v95, v15, v33
  v_add_f32_dpp v34, v30, v30 row_ror:8 row_mask:0xf bank_mask:0x3
  s_nop 0
  v_add_f32_dpp v35, v32, v32 row_ror:8 row_mask:0xf bank_mask:0x3
  v_add_f32_dpp v34, v31, v31 row_ror:8 row_mask:0xf bank_mask:0xc
  s_nop 0
  v_add_f32_dpp v35, v33, v33 row_ror:8 row_mask:0xf bank_mask:0xc
  s_mov_b32 s86, s80
  s_add_u32 s80, s80, 32768
  buffer_load_dwordx4 v[48:51], v2, s[28:31], s86 offen offset:0 nt
  buffer_load_dwordx4 v[52:55], v2, s[28:31], s86 offen offset:1024 nt
  buffer_load_dwordx4 v[56:59], v2, s[28:31], s86 offen offset:2048 nt
  buffer_load_dwordx4 v[60:63], v2, s[28:31], s86 offen offset:3072 nt
  v_add_f32_dpp v36, v34, v34 row_half_mirror row_mask:0xf bank_mask:0x5
  s_nop 1
  v_add_f32_dpp v36, v35, v35 row_half_mirror row_mask:0xf bank_mask:0xa
  s_nop 1
  v_add_f32_dpp v36, v36, v36 quad_perm:[1,0,3,2] row_mask:0xf bank_mask:0xf
  s_nop 1
  v_add_f32_dpp v36, v36, v36 quad_perm:[2,3,0,1] row_mask:0xf bank_mask:0xf
  v_cvt_pk_bf16_f32 v37, v36, v36
  v_and_b32 v37, 0xffff0000, v37
  v_mul_f32 v37, 0x3db504f3, v37
  v_cvt_pk_bf16_f32 v37, v37, v37
  v_and_b32 v37, 0xffff0000, v37
  v_mul_f32 v38, 0x3fb8aa3b, v37
  s_nop 1
  v_max_f32_dpp v39, v38, v38 row_ror:4 row_mask:0xf bank_mask:0xf
  s_nop 1
  v_max_f32_dpp v39, v39, v39 row_ror:8 row_mask:0xf bank_mask:0xf
  v_cmp_gt_f32 vcc, v39, v24
  s_cbranch_vccz L_nors_13
  v_max_f32 v39, v39, v24
  v_sub_f32 v43, v24, v39
  v_exp_f32 v43, v43
  v_mov_b32 v24, v39
  v_mul_f32 v25, v25, v43
  v_mul_f32 v16, v16, v43
  v_mul_f32 v17, v17, v43
  v_mul_f32 v18, v18, v43
  v_mul_f32 v19, v19, v43
  v_mul_f32 v20, v20, v43
  v_mul_f32 v21, v21, v43
  v_mul_f32 v22, v22, v43
  v_mul_f32 v23, v23, v43
L_nors_13:
  v_sub_f32 v40, v38, v24
  v_exp_f32 v40, v40
  s_nop 0
  v_cvt_pk_bf16_f32 v41, v40, 0
  v_add_f32 v25, v25, v40
  v_lshlrev_b32 v42, 16, v41
  s_waitcnt vmcnt(4)
  v_dot2c_f32_bf16_dpp v16, v41, v96 row_newbcast:0 row_mask:0xf bank_mask:0xf
  v_dot2c_f32_bf16_dpp v18, v41, v97 row_newbcast:0 row_mask:0xf bank_mask:0xf
  v_dot2c_f32_bf16_dpp v20, v41, v98 row_newbcast:0 row_mask:0xf bank_mask:0xf
  v_dot2c_f32_bf16_dpp v22, v41, v99 row_newbcast:0 row_mask:0xf bank_mask:0xf
  v_dot2c_f32_bf16_dpp v17, v42, v96 row_newbcast:0 row_mask:0xf bank_mask:0xf
  v_dot2c_f32_bf16_dpp v19, v42, v97 row_newbcast:0 row_mask:0xf bank_mask:0xf
  v_dot2c_f32_bf16_dpp v21, v42, v98 row_newbcast:0 row_mask:0xf bank_mask:0xf
  v_dot2c_f32_bf16_dpp v23, v42, v99 row_newbcast:0 row_mask:0xf bank_mask:0xf
  v_dot2c_f32_bf16_dpp v16, v41, v100 row_newbcast:8 row_mask:0xf bank_mask:0xf
  v_dot2c_f32_bf16_dpp v18, v41, v101 row_newbcast:8 row_mask:0xf bank_mask:0xf
  v_dot2c_f32_bf16_dpp v20, v41, v102 row_newbcast:8 row_mask:0xf bank_mask:0xf
  v_dot2c_f32_bf16_dpp v22, v41, v103 row_newbcast:8 row_mask:0xf bank_mask:0xf
  v_dot2c_f32_bf16_dpp v17, v42, v100 row_newbcast:8 row_mask:0xf bank_mask:0xf
  v_dot2c_f32_bf16_dpp v19, v42, v101 row_newbcast:8 row_mask:0xf bank_mask:0xf
  v_dot2c_f32_bf16_dpp v21, v42, v102 row_newbcast:8 row_mask:0xf bank_mask:0xf
  v_dot2c_f32_bf16_dpp v23, v42, v103 row_newbcast:8 row_mask:0xf bank_mask:0xf
  v_dot2c_f32_bf16_dpp v16, v41, v104 row_newbcast:4 row_mask:0xf bank_mask:0xf
  v_dot2c_f32_bf16_dpp v18, v41, v105 row_newbcast:4 row_mask:0xf bank_mask:0xf
  v_dot2c_f32_bf16_dpp v20, v41, v106 row_newbcast:4 row_mask:0xf bank_mask:0xf
  v_dot2c_f32_bf16_dpp v22, v41, v107 row_newbcast:4 row_mask:0xf bank_mask:0xf
  v_dot2c_f32_bf16_dpp v17, v42, v104 row_newbcast:4 row_mask:0xf bank_mask:0xf
  v_dot2c_f32_bf16_dpp v19, v42, v105 row_newbcast:4 row_mask:0xf bank_mask:0xf
  v_dot2c_f32_bf16_dpp v21, v42, v106 row_newbcast:4 row_mask:0xf bank_mask:0xf
  v_dot2c_f32_bf16_dpp v23, v42, v107 row_newbcast:4 row_mask:0xf bank_mask:0xf
  v_dot2c_f32_bf16_dpp v16, v41, v108 row_newbcast:12 row_mask:0xf bank_mask:0xf
  v_dot2c_f32_bf16_dpp v18, v41, v109 row_newbcast:12 row_mask:0xf bank_mask:0xf
  v_dot2c_f32_bf16_dpp v20, v41, v110 row_newbcast:12 row_mask:0xf bank_mask:0xf
  v_dot2c_f32_bf16_dpp v22, v41, v111 row_newbcast:12 row_mask:0xf bank_mask:0xf
  v_dot2c_f32_bf16_dpp v17, v42, v108 row_newbcast:12 row_mask:0xf bank_mask:0xf
  v_dot2c_f32_bf16_dpp v19, v42, v109 row_newbcast:12 row_mask:0xf bank_mask:0xf
  v_dot2c_f32_bf16_dpp v21, v42, v110 row_newbcast:12 row_mask:0xf bank_mask:0xf
  v_dot2c_f32_bf16_dpp v23, v42, v111 row_newbcast:12 row_mask:0xf bank_mask:0xf
  buffer_load_dwordx4 v[64:67], v2, s[32:35], s86 offen offset:0 nt
  buffer_load_dwordx4 v[68:71], v2, s[32:35], s86 offen offset:1024 nt
  buffer_load_dwordx4 v[72:75], v2, s[32:35], s86 offen offset:2048 nt
  buffer_load_dwordx4 v[76:79], v2, s[32:35], s86 offen offset:3072 nt
  s_waitcnt vmcnt(4)
  v_dot2_f32_bf16 v30, v48, v12, 0
  v_dot2_f32_bf16 v31, v52, v12, 0
  v_dot2_f32_bf16 v32, v56, v12, 0
  v_dot2_f32_bf16 v33, v60, v12, 0
  v_dot2_f32_bf16 v30, v49, v13, v30
  v_dot2_f32_bf16 v31, v53, v13, v31
  v_dot2_f32_bf16 v32, v57, v13, v32
  v_dot2_f32_bf16 v33, v61, v13, v33
  v_dot2_f32_bf16 v30, v50, v14, v30
  v_dot2_f32_bf16 v31, v54, v14, v31
  v_dot2_f32_bf16 v32, v58, v14, v32
  v_dot2_f32_bf16 v33, v62, v14, v33
  v_dot2_f32_bf16 v30, v51, v15, v30
  v_dot2_f32_bf16 v31, v55, v15, v31
  v_dot2_f32_bf16 v32, v59, v15, v32
  v_dot2_f32_bf16 v33, v63, v15, v33
  v_add_f32_dpp v34, v30, v30 row_ror:8 row_mask:0xf bank_mask:0x3
  s_nop 0
  v_add_f32_dpp v35, v32, v32 row_ror:8 row_mask:0xf bank_mask:0x3
  v_add_f32_dpp v34, v31, v31 row_ror:8 row_mask:0xf bank_mask:0xc
  s_nop 0
  v_add_f32_dpp v35, v33, v33 row_ror:8 row_mask:0xf bank_mask:0xc
  s_mov_b32 s87, s80
  s_add_u32 s80, s80, 32768
  buffer_load_dwordx4 v[80:83], v2, s[28:31], s87 offen offset:0 nt
  buffer_load_dwordx4 v[84:87], v2, s[28:31], s87 offen offset:1024 nt
  buffer_load_dwordx4 v[88:91], v2, s[28:31], s87 offen offset:2048 nt
  buffer_load_dwordx4 v[92:95], v2, s[28:31], s87 offen offset:3072 nt
  v_cmp_gt_u32 vcc, 64, v44
  s_cbranch_vccz L_chk_ok_14
  s_mov_b32 s82, 2097152
L_chk_spin_15:
  buffer_load_dword v44, v198, s[64:67], 0 offen sc1
  s_waitcnt vmcnt(0)
  s_sub_u32 s82, s82, 1
  s_cmp_eq_u32 s82, 0
  s_cbranch_scc1 L_chk_ok_14
  v_cmp_gt_u32 vcc, 64, v44
  s_cbranch_vccnz L_chk_spin_15
L_chk_ok_14:
  v_add_f32_dpp v36, v34, v34 row_half_mirror row_mask:0xf bank_mask:0x5
  s_nop 1
  v_add_f32_dpp v36, v35, v35 row_half_mirror row_mask:0xf bank_mask:0xa
  s_nop 1
  v_add_f32_dpp v36, v36, v36 quad_perm:[1,0,3,2] row_mask:0xf bank_mask:0xf
  s_nop 1
  v_add_f32_dpp v36, v36, v36 quad_perm:[2,3,0,1] row_mask:0xf bank_mask:0xf
  v_cvt_pk_bf16_f32 v37, v36, v36
  v_and_b32 v37, 0xffff0000, v37
  v_mul_f32 v37, 0x3db504f3, v37
  v_cvt_pk_bf16_f32 v37, v37, v37
  v_and_b32 v37, 0xffff0000, v37
  v_mul_f32 v38, 0x3fb8aa3b, v37
  s_nop 1
  v_max_f32_dpp v39, v38, v38 row_ror:4 row_mask:0xf bank_mask:0xf
  s_nop 1
  v_max_f32_dpp v39, v39, v39 row_ror:8 row_mask:0xf bank_mask:0xf
  v_cmp_gt_f32 vcc, v39, v24
  s_cbranch_vccz L_nors_16
  v_max_f32 v39, v39, v24
  v_sub_f32 v43, v24, v39
  v_exp_f32 v43, v43
  v_mov_b32 v24, v39
  v_mul_f32 v25, v25, v43
  v_mul_f32 v16, v16, v43
  v_mul_f32 v17, v17, v43
  v_mul_f32 v18, v18, v43
  v_mul_f32 v19, v19, v43
  v_mul_f32 v20, v20, v43
  v_mul_f32 v21, v21, v43
  v_mul_f32 v22, v22, v43
  v_mul_f32 v23, v23, v43
L_nors_16:
  v_sub_f32 v40, v38, v24
  v_exp_f32 v40, v40
  s_nop 0
  v_cvt_pk_bf16_f32 v41, v40, 0
  v_add_f32 v25, v25, v40
  v_lshlrev_b32 v42, 16, v41
  s_waitcnt vmcnt(4)
  v_dot2c_f32_bf16_dpp v16, v41, v64 row_newbcast:0 row_mask:0xf bank_mask:0xf
  v_dot2c_f32_bf16_dpp v18, v41, v65 row_newbcast:0 row_mask:0xf bank_mask:0xf
  v_dot2c_f32_bf16_dpp v20, v41, v66 row_newbcast:0 row_mask:0xf bank_mask:0xf
  v_dot2c_f32_bf16_dpp v22, v41, v67 row_newbcast:0 row_mask:0xf bank_mask:0xf
  v_dot2c_f32_bf16_dpp v17, v42, v64 row_newbcast:0 row_mask:0xf bank_mask:0xf
  v_dot2c_f32_bf16_dpp v19, v42, v65 row_newbcast:0 row_mask:0xf bank_mask:0xf
  v_dot2c_f32_bf16_dpp v21, v42, v66 row_newbcast:0 row_mask:0xf bank_mask:0xf
  v_dot2c_f32_bf16_dpp v23, v42, v67 row_newbcast:0 row_mask:0xf bank_mask:0xf
  v_dot2c_f32_bf16_dpp v16, v41, v68 row_newbcast:8 row_mask:0xf bank_mask:0xf
  v_dot2c_f32_bf16_dpp v18, v41, v69 row_newbcast:8 row_mask:0xf bank_mask:0xf
  v_dot2c_f32_bf16_dpp v20, v41, v70 row_newbcast:8 row_mask:0xf bank_mask:0xf
  v_dot2c_f32_bf16_dpp v22, v41, v71 row_newbcast:8 row_mask:0xf bank_mask:0xf
  v_dot2c_f32_bf16_dpp v17, v42, v68 row_newbcast:8 row_mask:0xf bank_mask:0xf
  v_dot2c_f32_bf16_dpp v19, v42, v69 row_newbcast:8 row_mask:0xf bank_mask:0xf
  v_dot2c_f32_bf16_dpp v21, v42, v70 row_newbcast:8 row_mask:0xf bank_mask:0xf
  v_dot2c_f32_bf16_dpp v23, v42, v71 row_newbcast:8 row_mask:0xf bank_mask:0xf
  v_dot2c_f32_bf16_dpp v16, v41, v72 row_newbcast:4 row_mask:0xf bank_mask:0xf
  v_dot2c_f32_bf16_dpp v18, v41, v73 row_newbcast:4 row_mask:0xf bank_mask:0xf
  v_dot2c_f32_bf16_dpp v20, v41, v74 row_newbcast:4 row_mask:0xf bank_mask:0xf
  v_dot2c_f32_bf16_dpp v22, v41, v75 row_newbcast:4 row_mask:0xf bank_mask:0xf
  v_dot2c_f32_bf16_dpp v17, v42, v72 row_newbcast:4 row_mask:0xf bank_mask:0xf
  v_dot2c_f32_bf16_dpp v19, v42, v73 row_newbcast:4 row_mask:0xf bank_mask:0xf
  v_dot2c_f32_bf16_dpp v21, v42, v74 row_newbcast:4 row_mask:0xf bank_mask:0xf
  v_dot2c_f32_bf16_dpp v23, v42, v75 row_newbcast:4 row_mask:0xf bank_mask:0xf
  v_dot2c_f32_bf16_dpp v16, v41, v76 row_newbcast:12 row_mask:0xf bank_mask:0xf
  v_dot2c_f32_bf16_dpp v18, v41, v77 row_newbcast:12 row_mask:0xf bank_mask:0xf
  v_dot2c_f32_bf16_dpp v20, v41, v78 row_newbcast:12 row_mask:0xf bank_mask:0xf
  v_dot2c_f32_bf16_dpp v22, v41, v79 row_newbcast:12 row_mask:0xf bank_mask:0xf
  v_dot2c_f32_bf16_dpp v17, v42, v76 row_newbcast:12 row_mask:0xf bank_mask:0xf
  v_dot2c_f32_bf16_dpp v19, v42, v77 row_newbcast:12 row_mask:0xf bank_mask:0xf
  v_dot2c_f32_bf16_dpp v21, v42, v78 row_newbcast:12 row_mask:0xf bank_mask:0xf
  v_dot2c_f32_bf16_dpp v23, v42, v79 row_newbcast:12 row_mask:0xf bank_mask:0xf
  buffer_load_dwordx4 v[96:99], v2, s[32:35], s87 offen offset:0 nt
  buffer_load_dwordx4 v[100:103], v2, s[32:35], s87 offen offset:1024 nt
  buffer_load_dwordx4 v[104:107], v2, s[32:35], s87 offen offset:2048 nt
  buffer_load_dwordx4 v[108:111], v2, s[32:35], s87 offen offset:3072 nt
  s_waitcnt vmcnt(4)
  v_dot2_f32_bf16 v30, v80, v12, 0
  v_dot2_f32_bf16 v31, v84, v12, 0
  v_dot2_f32_bf16 v32, v88, v12, 0
  v_dot2_f32_bf16 v33, v92, v12, 0
  v_dot2_f32_bf16 v30, v81, v13, v30
  v_dot2_f32_bf16 v31, v85, v13, v31
  v_dot2_f32_bf16 v32, v89, v13, v32
  v_dot2_f32_bf16 v33, v93, v13, v33
  v_dot2_f32_bf16 v30, v82, v14, v30
  v_dot2_f32_bf16 v31, v86, v14, v31
  v_dot2_f32_bf16 v32, v90, v14, v32
  v_dot2_f32_bf16 v33, v94, v14, v33
  v_dot2_f32_bf16 v30, v83, v15, v30
  v_dot2_f32_bf16 v31, v87, v15, v31
  v_dot2_f32_bf16 v32, v91, v15, v32
  v_dot2_f32_bf16 v33, v95, v15, v33
  v_add_f32_dpp v34, v30, v30 row_ror:8 row_mask:0xf bank_mask:0x3
  s_nop 0
  v_add_f32_dpp v35, v32, v32 row_ror:8 row_mask:0xf bank_mask:0x3
  v_add_f32_dpp v34, v31, v31 row_ror:8 row_mask:0xf bank_mask:0xc
  s_nop 0
  v_add_f32_dpp v35, v33, v33 row_ror:8 row_mask:0xf bank_mask:0xc
  s_mov_b32 s86, s80
  s_add_u32 s80, s80, 32768
  buffer_load_dwordx4 v[48:51], v2, s[28:31], s86 offen offset:0 nt
  buffer_load_dwordx4 v[52:55], v2, s[28:31], s86 offen offset:1024 nt
  buffer_load_dwordx4 v[56:59], v2, s[28:31], s86 offen offset:2048 nt
  buffer_load_dwordx4 v[60:63], v2, s[28:31], s86 offen offset:3072 nt
  v_add_f32_dpp v36, v34, v34 row_half_mirror row_mask:0xf bank_mask:0x5
  s_nop 1
  v_add_f32_dpp v36, v35, v35 row_half_mirror row_mask:0xf bank_mask:0xa
  s_nop 1
  v_add_f32_dpp v36, v36, v36 quad_perm:[1,0,3,2] row_mask:0xf bank_mask:0xf
  s_nop 1
  v_add_f32_dpp v36, v36, v36 quad_perm:[2,3,0,1] row_mask:0xf bank_mask:0xf
  v_cvt_pk_bf16_f32 v37, v36, v36
  v_and_b32 v37, 0xffff0000, v37
  v_mul_f32 v37, 0x3db504f3, v37
  v_cvt_pk_bf16_f32 v37, v37, v37
  v_and_b32 v37, 0xffff0000, v37
  v_mul_f32 v38, 0x3fb8aa3b, v37
  s_nop 1
  v_max_f32_dpp v39, v38, v38 row_ror:4 row_mask:0xf bank_mask:0xf
  s_nop 1
  v_max_f32_dpp v39, v39, v39 row_ror:8 row_mask:0xf bank_mask:0xf
  v_cmp_gt_f32 vcc, v39, v24
  s_cbranch_vccz L_nors_17
  v_max_f32 v39, v39, v24
  v_sub_f32 v43, v24, v39
  v_exp_f32 v43, v43
  v_mov_b32 v24, v39
  v_mul_f32 v25, v25, v43
  v_mul_f32 v16, v16, v43
  v_mul_f32 v17, v17, v43
  v_mul_f32 v18, v18, v43
  v_mul_f32 v19, v19, v43
  v_mul_f32 v20, v20, v43
  v_mul_f32 v21, v21, v43
  v_mul_f32 v22, v22, v43
  v_mul_f32 v23, v23, v43
L_nors_17:
  v_sub_f32 v40, v38, v24
  v_exp_f32 v40, v40
  s_nop 0
  v_cvt_pk_bf16_f32 v41, v40, 0
  v_add_f32 v25, v25, v40
  v_lshlrev_b32 v42, 16, v41
  s_waitcnt vmcnt(4)
  v_dot2c_f32_bf16_dpp v16, v41, v96 row_newbcast:0 row_mask:0xf bank_mask:0xf
  v_dot2c_f32_bf16_dpp v18, v41, v97 row_newbcast:0 row_mask:0xf bank_mask:0xf
  v_dot2c_f32_bf16_dpp v20, v41, v98 row_newbcast:0 row_mask:0xf bank_mask:0xf
  v_dot2c_f32_bf16_dpp v22, v41, v99 row_newbcast:0 row_mask:0xf bank_mask:0xf
  v_dot2c_f32_bf16_dpp v17, v42, v96 row_newbcast:0 row_mask:0xf bank_mask:0xf
  v_dot2c_f32_bf16_dpp v19, v42, v97 row_newbcast:0 row_mask:0xf bank_mask:0xf
  v_dot2c_f32_bf16_dpp v21, v42, v98 row_newbcast:0 row_mask:0xf bank_mask:0xf
  v_dot2c_f32_bf16_dpp v23, v42, v99 row_newbcast:0 row_mask:0xf bank_mask:0xf
  v_dot2c_f32_bf16_dpp v16, v41, v100 row_newbcast:8 row_mask:0xf bank_mask:0xf
  v_dot2c_f32_bf16_dpp v18, v41, v101 row_newbcast:8 row_mask:0xf bank_mask:0xf
  v_dot2c_f32_bf16_dpp v20, v41, v102 row_newbcast:8 row_mask:0xf bank_mask:0xf
  v_dot2c_f32_bf16_dpp v22, v41, v103 row_newbcast:8 row_mask:0xf bank_mask:0xf
  v_dot2c_f32_bf16_dpp v17, v42, v100 row_newbcast:8 row_mask:0xf bank_mask:0xf
  v_dot2c_f32_bf16_dpp v19, v42, v101 row_newbcast:8 row_mask:0xf bank_mask:0xf
  v_dot2c_f32_bf16_dpp v21, v42, v102 row_newbcast:8 row_mask:0xf bank_mask:0xf
  v_dot2c_f32_bf16_dpp v23, v42, v103 row_newbcast:8 row_mask:0xf bank_mask:0xf
  v_dot2c_f32_bf16_dpp v16, v41, v104 row_newbcast:4 row_mask:0xf bank_mask:0xf
  v_dot2c_f32_bf16_dpp v18, v41, v105 row_newbcast:4 row_mask:0xf bank_mask:0xf
  v_dot2c_f32_bf16_dpp v20, v41, v106 row_newbcast:4 row_mask:0xf bank_mask:0xf
  v_dot2c_f32_bf16_dpp v22, v41, v107 row_newbcast:4 row_mask:0xf bank_mask:0xf
  v_dot2c_f32_bf16_dpp v17, v42, v104 row_newbcast:4 row_mask:0xf bank_mask:0xf
  v_dot2c_f32_bf16_dpp v19, v42, v105 row_newbcast:4 row_mask:0xf bank_mask:0xf
  v_dot2c_f32_bf16_dpp v21, v42, v106 row_newbcast:4 row_mask:0xf bank_mask:0xf
  v_dot2c_f32_bf16_dpp v23, v42, v107 row_newbcast:4 row_mask:0xf bank_mask:0xf
  v_dot2c_f32_bf16_dpp v16, v41, v108 row_newbcast:12 row_mask:0xf bank_mask:0xf
  v_dot2c_f32_bf16_dpp v18, v41, v109 row_newbcast:12 row_mask:0xf bank_mask:0xf
  v_dot2c_f32_bf16_dpp v20, v41, v110 row_newbcast:12 row_mask:0xf bank_mask:0xf
  v_dot2c_f32_bf16_dpp v22, v41, v111 row_newbcast:12 row_mask:0xf bank_mask:0xf
  v_dot2c_f32_bf16_dpp v17, v42, v108 row_newbcast:12 row_mask:0xf bank_mask:0xf
  v_dot2c_f32_bf16_dpp v19, v42, v109 row_newbcast:12 row_mask:0xf bank_mask:0xf
  v_dot2c_f32_bf16_dpp v21, v42, v110 row_newbcast:12 row_mask:0xf bank_mask:0xf
  v_dot2c_f32_bf16_dpp v23, v42, v111 row_newbcast:12 row_mask:0xf bank_mask:0xf
  buffer_load_dwordx4 v[64:67], v2, s[32:35], s86 offen offset:0 nt
  buffer_load_dwordx4 v[68:71], v2, s[32:35], s86 offen offset:1024 nt
  buffer_load_dwordx4 v[72:75], v2, s[32:35], s86 offen offset:2048 nt
  buffer_load_dwordx4 v[76:79], v2, s[32:35], s86 offen offset:3072 nt
L_after_peel:
  s_mov_b32 s81, 17
L_static:
  s_waitcnt vmcnt(4)
  v_dot2_f32_bf16 v30, v48, v12, 0
  v_dot2_f32_bf16 v31, v52, v12, 0
  v_dot2_f32_bf16 v32, v56, v12, 0
  v_dot2_f32_bf16 v33, v60, v12, 0
  v_dot2_f32_bf16 v30, v49, v13, v30
  v_dot2_f32_bf16 v31, v53, v13, v31
  v_dot2_f32_bf16 v32, v57, v13, v32
  v_dot2_f32_bf16 v33, v61, v13, v33
  v_dot2_f32_bf16 v30, v50, v14, v30
  v_dot2_f32_bf16 v31, v54, v14, v31
  v_dot2_f32_bf16 v32, v58, v14, v32
  v_dot2_f32_bf16 v33, v62, v14, v33
  v_dot2_f32_bf16 v30, v51, v15, v30
  v_dot2_f32_bf16 v31, v55, v15, v31
  v_dot2_f32_bf16 v32, v59, v15, v32
  v_dot2_f32_bf16 v33, v63, v15, v33
  v_add_f32_dpp v34, v30, v30 row_ror:8 row_mask:0xf bank_mask:0x3
  s_nop 0
  v_add_f32_dpp v35, v32, v32 row_ror:8 row_mask:0xf bank_mask:0x3
  v_add_f32_dpp v34, v31, v31 row_ror:8 row_mask:0xf bank_mask:0xc
  s_nop 0
  v_add_f32_dpp v35, v33, v33 row_ror:8 row_mask:0xf bank_mask:0xc
  s_mov_b32 s87, s80
  s_add_u32 s80, s80, 32768
  buffer_load_dwordx4 v[80:83], v2, s[28:31], s87 offen offset:0 nt
  buffer_load_dwordx4 v[84:87], v2, s[28:31], s87 offen offset:1024 nt
  buffer_load_dwordx4 v[88:91], v2, s[28:31], s87 offen offset:2048 nt
  buffer_load_dwordx4 v[92:95], v2, s[28:31], s87 offen offset:3072 nt
  v_add_f32_dpp v36, v34, v34 row_half_mirror row_mask:0xf bank_mask:0x5
  s_nop 1
  v_add_f32_dpp v36, v35, v35 row_half_mirror row_mask:0xf bank_mask:0xa
  s_nop 1
  v_add_f32_dpp v36, v36, v36 quad_perm:[1,0,3,2] row_mask:0xf bank_mask:0xf
  s_nop 1
  v_add_f32_dpp v36, v36, v36 quad_perm:[2,3,0,1] row_mask:0xf bank_mask:0xf
  v_cvt_pk_bf16_f32 v37, v36, v36
  v_and_b32 v37, 0xffff0000, v37
  v_mul_f32 v37, 0x3db504f3, v37
  v_cvt_pk_bf16_f32 v37, v37, v37
  v_and_b32 v37, 0xffff0000, v37
  v_mul_f32 v38, 0x3fb8aa3b, v37
  s_nop 1
  v_max_f32_dpp v39, v38, v38 row_ror:4 row_mask:0xf bank_mask:0xf
  s_nop 1
  v_max_f32_dpp v39, v39, v39 row_ror:8 row_mask:0xf bank_mask:0xf
  v_cmp_gt_f32 vcc, v39, v24
  s_cbranch_vccz L_nors_18
  v_max_f32 v39, v39, v24
  v_sub_f32 v43, v24, v39
  v_exp_f32 v43, v43
  v_mov_b32 v24, v39
  v_mul_f32 v25, v25, v43
  v_mul_f32 v16, v16, v43
  v_mul_f32 v17, v17, v43
  v_mul_f32 v18, v18, v43
  v_mul_f32 v19, v19, v43
  v_mul_f32 v20, v20, v43
  v_mul_f32 v21, v21, v43
  v_mul_f32 v22, v22, v43
  v_mul_f32 v23, v23, v43
L_nors_18:
  v_sub_f32 v40, v38, v24
  v_exp_f32 v40, v40
  s_nop 0
  v_cvt_pk_bf16_f32 v41, v40, 0
  v_add_f32 v25, v25, v40
  v_lshlrev_b32 v42, 16, v41
  s_waitcnt vmcnt(4)
  v_dot2c_f32_bf16_dpp v16, v41, v64 row_newbcast:0 row_mask:0xf bank_mask:0xf
  v_dot2c_f32_bf16_dpp v18, v41, v65 row_newbcast:0 row_mask:0xf bank_mask:0xf
  v_dot2c_f32_bf16_dpp v20, v41, v66 row_newbcast:0 row_mask:0xf bank_mask:0xf
  v_dot2c_f32_bf16_dpp v22, v41, v67 row_newbcast:0 row_mask:0xf bank_mask:0xf
  v_dot2c_f32_bf16_dpp v17, v42, v64 row_newbcast:0 row_mask:0xf bank_mask:0xf
  v_dot2c_f32_bf16_dpp v19, v42, v65 row_newbcast:0 row_mask:0xf bank_mask:0xf
  v_dot2c_f32_bf16_dpp v21, v42, v66 row_newbcast:0 row_mask:0xf bank_mask:0xf
  v_dot2c_f32_bf16_dpp v23, v42, v67 row_newbcast:0 row_mask:0xf bank_mask:0xf
  v_dot2c_f32_bf16_dpp v16, v41, v68 row_newbcast:8 row_mask:0xf bank_mask:0xf
  v_dot2c_f32_bf16_dpp v18, v41, v69 row_newbcast:8 row_mask:0xf bank_mask:0xf
  v_dot2c_f32_bf16_dpp v20, v41, v70 row_newbcast:8 row_mask:0xf bank_mask:0xf
  v_dot2c_f32_bf16_dpp v22, v41, v71 row_newbcast:8 row_mask:0xf bank_mask:0xf
  v_dot2c_f32_bf16_dpp v17, v42, v68 row_newbcast:8 row_mask:0xf bank_mask:0xf
  v_dot2c_f32_bf16_dpp v19, v42, v69 row_newbcast:8 row_mask:0xf bank_mask:0xf
  v_dot2c_f32_bf16_dpp v21, v42, v70 row_newbcast:8 row_mask:0xf bank_mask:0xf
  v_dot2c_f32_bf16_dpp v23, v42, v71 row_newbcast:8 row_mask:0xf bank_mask:0xf
  v_dot2c_f32_bf16_dpp v16, v41, v72 row_newbcast:4 row_mask:0xf bank_mask:0xf
  v_dot2c_f32_bf16_dpp v18, v41, v73 row_newbcast:4 row_mask:0xf bank_mask:0xf
  v_dot2c_f32_bf16_dpp v20, v41, v74 row_newbcast:4 row_mask:0xf bank_mask:0xf
  v_dot2c_f32_bf16_dpp v22, v41, v75 row_newbcast:4 row_mask:0xf bank_mask:0xf
  v_dot2c_f32_bf16_dpp v17, v42, v72 row_newbcast:4 row_mask:0xf bank_mask:0xf
  v_dot2c_f32_bf16_dpp v19, v42, v73 row_newbcast:4 row_mask:0xf bank_mask:0xf
  v_dot2c_f32_bf16_dpp v21, v42, v74 row_newbcast:4 row_mask:0xf bank_mask:0xf
  v_dot2c_f32_bf16_dpp v23, v42, v75 row_newbcast:4 row_mask:0xf bank_mask:0xf
  v_dot2c_f32_bf16_dpp v16, v41, v76 row_newbcast:12 row_mask:0xf bank_mask:0xf
  v_dot2c_f32_bf16_dpp v18, v41, v77 row_newbcast:12 row_mask:0xf bank_mask:0xf
  v_dot2c_f32_bf16_dpp v20, v41, v78 row_newbcast:12 row_mask:0xf bank_mask:0xf
  v_dot2c_f32_bf16_dpp v22, v41, v79 row_newbcast:12 row_mask:0xf bank_mask:0xf
  v_dot2c_f32_bf16_dpp v17, v42, v76 row_newbcast:12 row_mask:0xf bank_mask:0xf
  v_dot2c_f32_bf16_dpp v19, v42, v77 row_newbcast:12 row_mask:0xf bank_mask:0xf
  v_dot2c_f32_bf16_dpp v21, v42, v78 row_newbcast:12 row_mask:0xf bank_mask:0xf
  v_dot2c_f32_bf16_dpp v23, v42, v79 row_newbcast:12 row_mask:0xf bank_mask:0xf
  buffer_load_dwordx4 v[96:99], v2, s[32:35], s87 offen offset:0 nt
  buffer_load_dwordx4 v[100:103], v2, s[32:35], s87 offen offset:1024 nt
  buffer_load_dwordx4 v[104:107], v2, s[32:35], s87 offen offset:2048 nt
  buffer_load_dwordx4 v[108:111], v2, s[32:35], s87 offen offset:3072 nt
  s_waitcnt vmcnt(4)
  v_dot2_f32_bf16 v30, v80, v12, 0
  v_dot2_f32_bf16 v31, v84, v12, 0
  v_dot2_f32_bf16 v32, v88, v12, 0
  v_dot2_f32_bf16 v33, v92, v12, 0
  v_dot2_f32_bf16 v30, v81, v13, v30
  v_dot2_f32_bf16 v31, v85, v13, v31
  v_dot2_f32_bf16 v32, v89, v13, v32
  v_dot2_f32_bf16 v33, v93, v13, v33
  v_dot2_f32_bf16 v30, v82, v14, v30
  v_dot2_f32_bf16 v31, v86, v14, v31
  v_dot2_f32_bf16 v32, v90, v14, v32
  v_dot2_f32_bf16 v33, v94, v14, v33
  v_dot2_f32_bf16 v30, v83, v15, v30
  v_dot2_f32_bf16 v31, v87, v15, v31
  v_dot2_f32_bf16 v32, v91, v15, v32
  v_dot2_f32_bf16 v33, v95, v15, v33
  v_add_f32_dpp v34, v30, v30 row_ror:8 row_mask:0xf bank_mask:0x3
  s_nop 0
  v_add_f32_dpp v35, v32, v32 row_ror:8 row_mask:0xf bank_mask:0x3
  v_add_f32_dpp v34, v31, v31 row_ror:8 row_mask:0xf bank_mask:0xc
  s_nop 0
  v_add_f32_dpp v35, v33, v33 row_ror:8 row_mask:0xf bank_mask:0xc
  s_mov_b32 s86, s80
  s_add_u32 s80, s80, 32768
  buffer_load_dwordx4 v[48:51], v2, s[28:31], s86 offen offset:0 nt
  buffer_load_dwordx4 v[52:55], v2, s[28:31], s86 offen offset:1024 nt
  buffer_load_dwordx4 v[56:59], v2, s[28:31], s86 offen offset:2048 nt
  buffer_load_dwordx4 v[60:63], v2, s[28:31], s86 offen offset:3072 nt
  v_add_f32_dpp v36, v34, v34 row_half_mirror row_mask:0xf bank_mask:0x5
  s_nop 1
  v_add_f32_dpp v36, v35, v35 row_half_mirror row_mask:0xf bank_mask:0xa
  s_nop 1
  v_add_f32_dpp v36, v36, v36 quad_perm:[1,0,3,2] row_mask:0xf bank_mask:0xf
  s_nop 1
  v_add_f32_dpp v36, v36, v36 quad_perm:[2,3,0,1] row_mask:0xf bank_mask:0xf
  v_cvt_pk_bf16_f32 v37, v36, v36
  v_and_b32 v37, 0xffff0000, v37
  v_mul_f32 v37, 0x3db504f3, v37
  v_cvt_pk_bf16_f32 v37, v37, v37
  v_and_b32 v37, 0xffff0000, v37
  v_mul_f32 v38, 0x3fb8aa3b, v37
  s_nop 1
  v_max_f32_dpp v39, v38, v38 row_ror:4 row_mask:0xf bank_mask:0xf
  s_nop 1
  v_max_f32_dpp v39, v39, v39 row_ror:8 row_mask:0xf bank_mask:0xf
  v_cmp_gt_f32 vcc, v39, v24
  s_cbranch_vccz L_nors_19
  v_max_f32 v39, v39, v24
  v_sub_f32 v43, v24, v39
  v_exp_f32 v43, v43
  v_mov_b32 v24, v39
  v_mul_f32 v25, v25, v43
  v_mul_f32 v16, v16, v43
  v_mul_f32 v17, v17, v43
  v_mul_f32 v18, v18, v43
  v_mul_f32 v19, v19, v43
  v_mul_f32 v20, v20, v43
  v_mul_f32 v21, v21, v43
  v_mul_f32 v22, v22, v43
  v_mul_f32 v23, v23, v43
L_nors_19:
  v_sub_f32 v40, v38, v24
  v_exp_f32 v40, v40
  s_nop 0
  v_cvt_pk_bf16_f32 v41, v40, 0
  v_add_f32 v25, v25, v40
  v_lshlrev_b32 v42, 16, v41
  s_waitcnt vmcnt(4)
  v_dot2c_f32_bf16_dpp v16, v41, v96 row_newbcast:0 row_mask:0xf bank_mask:0xf
  v_dot2c_f32_bf16_dpp v18, v41, v97 row_newbcast:0 row_mask:0xf bank_mask:0xf
  v_dot2c_f32_bf16_dpp v20, v41, v98 row_newbcast:0 row_mask:0xf bank_mask:0xf
  v_dot2c_f32_bf16_dpp v22, v41, v99 row_newbcast:0 row_mask:0xf bank_mask:0xf
  v_dot2c_f32_bf16_dpp v17, v42, v96 row_newbcast:0 row_mask:0xf bank_mask:0xf
  v_dot2c_f32_bf16_dpp v19, v42, v97 row_newbcast:0 row_mask:0xf bank_mask:0xf
  v_dot2c_f32_bf16_dpp v21, v42, v98 row_newbcast:0 row_mask:0xf bank_mask:0xf
  v_dot2c_f32_bf16_dpp v23, v42, v99 row_newbcast:0 row_mask:0xf bank_mask:0xf
  v_dot2c_f32_bf16_dpp v16, v41, v100 row_newbcast:8 row_mask:0xf bank_mask:0xf
  v_dot2c_f32_bf16_dpp v18, v41, v101 row_newbcast:8 row_mask:0xf bank_mask:0xf
  v_dot2c_f32_bf16_dpp v20, v41, v102 row_newbcast:8 row_mask:0xf bank_mask:0xf
  v_dot2c_f32_bf16_dpp v22, v41, v103 row_newbcast:8 row_mask:0xf bank_mask:0xf
  v_dot2c_f32_bf16_dpp v17, v42, v100 row_newbcast:8 row_mask:0xf bank_mask:0xf
  v_dot2c_f32_bf16_dpp v19, v42, v101 row_newbcast:8 row_mask:0xf bank_mask:0xf
  v_dot2c_f32_bf16_dpp v21, v42, v102 row_newbcast:8 row_mask:0xf bank_mask:0xf
  v_dot2c_f32_bf16_dpp v23, v42, v103 row_newbcast:8 row_mask:0xf bank_mask:0xf
  v_dot2c_f32_bf16_dpp v16, v41, v104 row_newbcast:4 row_mask:0xf bank_mask:0xf
  v_dot2c_f32_bf16_dpp v18, v41, v105 row_newbcast:4 row_mask:0xf bank_mask:0xf
  v_dot2c_f32_bf16_dpp v20, v41, v106 row_newbcast:4 row_mask:0xf bank_mask:0xf
  v_dot2c_f32_bf16_dpp v22, v41, v107 row_newbcast:4 row_mask:0xf bank_mask:0xf
  v_dot2c_f32_bf16_dpp v17, v42, v104 row_newbcast:4 row_mask:0xf bank_mask:0xf
  v_dot2c_f32_bf16_dpp v19, v42, v105 row_newbcast:4 row_mask:0xf bank_mask:0xf
  v_dot2c_f32_bf16_dpp v21, v42, v106 row_newbcast:4 row_mask:0xf bank_mask:0xf
  v_dot2c_f32_bf16_dpp v23, v42, v107 row_newbcast:4 row_mask:0xf bank_mask:0xf
  v_dot2c_f32_bf16_dpp v16, v41, v108 row_newbcast:12 row_mask:0xf bank_mask:0xf
  v_dot2c_f32_bf16_dpp v18, v41, v109 row_newbcast:12 row_mask:0xf bank_mask:0xf
  v_dot2c_f32_bf16_dpp v20, v41, v110 row_newbcast:12 row_mask:0xf bank_mask:0xf
  v_dot2c_f32_bf16_dpp v22, v41, v111 row_newbcast:12 row_mask:0xf bank_mask:0xf
  v_dot2c_f32_bf16_dpp v17, v42, v108 row_newbcast:12 row_mask:0xf bank_mask:0xf
  v_dot2c_f32_bf16_dpp v19, v42, v109 row_newbcast:12 row_mask:0xf bank_mask:0xf
  v_dot2c_f32_bf16_dpp v21, v42, v110 row_newbcast:12 row_mask:0xf bank_mask:0xf
  v_dot2c_f32_bf16_dpp v23, v42, v111 row_newbcast:12 row_mask:0xf bank_mask:0xf
  buffer_load_dwordx4 v[64:67], v2, s[32:35], s86 offen offset:0 nt
  buffer_load_dwordx4 v[68:71], v2, s[32:35], s86 offen offset:1024 nt
  buffer_load_dwordx4 v[72:75], v2, s[32:35], s86 offen offset:2048 nt
  buffer_load_dwordx4 v[76:79], v2, s[32:35], s86 offen offset:3072 nt
  s_sub_u32 s81, s81, 1
  s_cmp_lg_u32 s81, 0
  s_cbranch_scc1 L_static
  s_waitcnt vmcnt(4)
  v_dot2_f32_bf16 v30, v48, v12, 0
  v_dot2_f32_bf16 v31, v52, v12, 0
  v_dot2_f32_bf16 v32, v56, v12, 0
  v_dot2_f32_bf16 v33, v60, v12, 0
  v_dot2_f32_bf16 v30, v49, v13, v30
  v_dot2_f32_bf16 v31, v53, v13, v31
  v_dot2_f32_bf16 v32, v57, v13, v32
  v_dot2_f32_bf16 v33, v61, v13, v33
  v_dot2_f32_bf16 v30, v50, v14, v30
  v_dot2_f32_bf16 v31, v54, v14, v31
  v_dot2_f32_bf16 v32, v58, v14, v32
  v_dot2_f32_bf16 v33, v62, v14, v33
  v_dot2_f32_bf16 v30, v51, v15, v30
  v_dot2_f32_bf16 v31, v55, v15, v31
  v_dot2_f32_bf16 v32, v59, v15, v32
  v_dot2_f32_bf16 v33, v63, v15, v33
  v_add_f32_dpp v34, v30, v30 row_ror:8 row_mask:0xf bank_mask:0x3
  s_nop 0
  v_add_f32_dpp v35, v32, v32 row_ror:8 row_mask:0xf bank_mask:0x3
  v_add_f32_dpp v34, v31, v31 row_ror:8 row_mask:0xf bank_mask:0xc
  s_nop 0
  v_add_f32_dpp v35, v33, v33 row_ror:8 row_mask:0xf bank_mask:0xc
  s_mov_b32 s87, s80
  s_add_u32 s80, s80, 32768
  buffer_load_dwordx4 v[80:83], v2, s[28:31], s87 offen offset:0 nt
  buffer_load_dwordx4 v[84:87], v2, s[28:31], s87 offen offset:1024 nt
  buffer_load_dwordx4 v[88:91], v2, s[28:31], s87 offen offset:2048 nt
  buffer_load_dwordx4 v[92:95], v2, s[28:31], s87 offen offset:3072 nt
  v_add_f32_dpp v36, v34, v34 row_half_mirror row_mask:0xf bank_mask:0x5
  s_nop 1
  v_add_f32_dpp v36, v35, v35 row_half_mirror row_mask:0xf bank_mask:0xa
  s_nop 1
  v_add_f32_dpp v36, v36, v36 quad_perm:[1,0,3,2] row_mask:0xf bank_mask:0xf
  s_nop 1
  v_add_f32_dpp v36, v36, v36 quad_perm:[2,3,0,1] row_mask:0xf bank_mask:0xf
  v_cvt_pk_bf16_f32 v37, v36, v36
  v_and_b32 v37, 0xffff0000, v37
  v_mul_f32 v37, 0x3db504f3, v37
  v_cvt_pk_bf16_f32 v37, v37, v37
  v_and_b32 v37, 0xffff0000, v37
  v_mul_f32 v38, 0x3fb8aa3b, v37
  s_nop 1
  v_max_f32_dpp v39, v38, v38 row_ror:4 row_mask:0xf bank_mask:0xf
  s_nop 1
  v_max_f32_dpp v39, v39, v39 row_ror:8 row_mask:0xf bank_mask:0xf
  v_cmp_gt_f32 vcc, v39, v24
  s_cbranch_vccz L_nors_20
  v_max_f32 v39, v39, v24
  v_sub_f32 v43, v24, v39
  v_exp_f32 v43, v43
  v_mov_b32 v24, v39
  v_mul_f32 v25, v25, v43
  v_mul_f32 v16, v16, v43
  v_mul_f32 v17, v17, v43
  v_mul_f32 v18, v18, v43
  v_mul_f32 v19, v19, v43
  v_mul_f32 v20, v20, v43
  v_mul_f32 v21, v21, v43
  v_mul_f32 v22, v22, v43
  v_mul_f32 v23, v23, v43
L_nors_20:
  v_sub_f32 v40, v38, v24
  v_exp_f32 v40, v40
  s_nop 0
  v_cvt_pk_bf16_f32 v41, v40, 0
  v_add_f32 v25, v25, v40
  v_lshlrev_b32 v42, 16, v41
  s_waitcnt vmcnt(4)
  v_dot2c_f32_bf16_dpp v16, v41, v64 row_newbcast:0 row_mask:0xf bank_mask:0xf
  v_dot2c_f32_bf16_dpp v18, v41, v65 row_newbcast:0 row_mask:0xf bank_mask:0xf
  v_dot2c_f32_bf16_dpp v20, v41, v66 row_newbcast:0 row_mask:0xf bank_mask:0xf
  v_dot2c_f32_bf16_dpp v22, v41, v67 row_newbcast:0 row_mask:0xf bank_mask:0xf
  v_dot2c_f32_bf16_dpp v17, v42, v64 row_newbcast:0 row_mask:0xf bank_mask:0xf
  v_dot2c_f32_bf16_dpp v19, v42, v65 row_newbcast:0 row_mask:0xf bank_mask:0xf
  v_dot2c_f32_bf16_dpp v21, v42, v66 row_newbcast:0 row_mask:0xf bank_mask:0xf
  v_dot2c_f32_bf16_dpp v23, v42, v67 row_newbcast:0 row_mask:0xf bank_mask:0xf
  v_dot2c_f32_bf16_dpp v16, v41, v68 row_newbcast:8 row_mask:0xf bank_mask:0xf
  v_dot2c_f32_bf16_dpp v18, v41, v69 row_newbcast:8 row_mask:0xf bank_mask:0xf
  v_dot2c_f32_bf16_dpp v20, v41, v70 row_newbcast:8 row_mask:0xf bank_mask:0xf
  v_dot2c_f32_bf16_dpp v22, v41, v71 row_newbcast:8 row_mask:0xf bank_mask:0xf
  v_dot2c_f32_bf16_dpp v17, v42, v68 row_newbcast:8 row_mask:0xf bank_mask:0xf
  v_dot2c_f32_bf16_dpp v19, v42, v69 row_newbcast:8 row_mask:0xf bank_mask:0xf
  v_dot2c_f32_bf16_dpp v21, v42, v70 row_newbcast:8 row_mask:0xf bank_mask:0xf
  v_dot2c_f32_bf16_dpp v23, v42, v71 row_newbcast:8 row_mask:0xf bank_mask:0xf
  v_dot2c_f32_bf16_dpp v16, v41, v72 row_newbcast:4 row_mask:0xf bank_mask:0xf
  v_dot2c_f32_bf16_dpp v18, v41, v73 row_newbcast:4 row_mask:0xf bank_mask:0xf
  v_dot2c_f32_bf16_dpp v20, v41, v74 row_newbcast:4 row_mask:0xf bank_mask:0xf
  v_dot2c_f32_bf16_dpp v22, v41, v75 row_newbcast:4 row_mask:0xf bank_mask:0xf
  v_dot2c_f32_bf16_dpp v17, v42, v72 row_newbcast:4 row_mask:0xf bank_mask:0xf
  v_dot2c_f32_bf16_dpp v19, v42, v73 row_newbcast:4 row_mask:0xf bank_mask:0xf
  v_dot2c_f32_bf16_dpp v21, v42, v74 row_newbcast:4 row_mask:0xf bank_mask:0xf
  v_dot2c_f32_bf16_dpp v23, v42, v75 row_newbcast:4 row_mask:0xf bank_mask:0xf
  v_dot2c_f32_bf16_dpp v16, v41, v76 row_newbcast:12 row_mask:0xf bank_mask:0xf
  v_dot2c_f32_bf16_dpp v18, v41, v77 row_newbcast:12 row_mask:0xf bank_mask:0xf
  v_dot2c_f32_bf16_dpp v20, v41, v78 row_newbcast:12 row_mask:0xf bank_mask:0xf
  v_dot2c_f32_bf16_dpp v22, v41, v79 row_newbcast:12 row_mask:0xf bank_mask:0xf
  v_dot2c_f32_bf16_dpp v17, v42, v76 row_newbcast:12 row_mask:0xf bank_mask:0xf
  v_dot2c_f32_bf16_dpp v19, v42, v77 row_newbcast:12 row_mask:0xf bank_mask:0xf
  v_dot2c_f32_bf16_dpp v21, v42, v78 row_newbcast:12 row_mask:0xf bank_mask:0xf
  v_dot2c_f32_bf16_dpp v23, v42, v79 row_newbcast:12 row_mask:0xf bank_mask:0xf
  buffer_load_dwordx4 v[96:99], v2, s[32:35], s87 offen offset:0 nt
  buffer_load_dwordx4 v[100:103], v2, s[32:35], s87 offen offset:1024 nt
  buffer_load_dwordx4 v[104:107], v2, s[32:35], s87 offen offset:2048 nt
  buffer_load_dwordx4 v[108:111], v2, s[32:35], s87 offen offset:3072 nt
  s_waitcnt vmcnt(4)
  v_dot2_f32_bf16 v30, v80, v12, 0
  v_dot2_f32_bf16 v31, v84, v12, 0
  v_dot2_f32_bf16 v32, v88, v12, 0
  v_dot2_f32_bf16 v33, v92, v12, 0
  v_dot2_f32_bf16 v30, v81, v13, v30
  v_dot2_f32_bf16 v31, v85, v13, v31
  v_dot2_f32_bf16 v32, v89, v13, v32
  v_dot2_f32_bf16 v33, v93, v13, v33
  v_dot2_f32_bf16 v30, v82, v14, v30
  v_dot2_f32_bf16 v31, v86, v14, v31
  v_dot2_f32_bf16 v32, v90, v14, v32
  v_dot2_f32_bf16 v33, v94, v14, v33
  v_dot2_f32_bf16 v30, v83, v15, v30
  v_dot2_f32_bf16 v31, v87, v15, v31
  v_dot2_f32_bf16 v32, v91, v15, v32
  v_dot2_f32_bf16 v33, v95, v15, v33
  v_add_f32_dpp v34, v30, v30 row_ror:8 row_mask:0xf bank_mask:0x3
  s_nop 0
  v_add_f32_dpp v35, v32, v32 row_ror:8 row_mask:0xf bank_mask:0x3
  v_add_f32_dpp v34, v31, v31 row_ror:8 row_mask:0xf bank_mask:0xc
  s_nop 0
  v_add_f32_dpp v35, v33, v33 row_ror:8 row_mask:0xf bank_mask:0xc
  s_mov_b32 s86, s80
  s_add_u32 s80, s80, 32768
  buffer_load_dwordx4 v[48:51], v2, s[28:31], s86 offen offset:0 nt
  buffer_load_dwordx4 v[52:55], v2, s[28:31], s86 offen offset:1024 nt
  buffer_load_dwordx4 v[56:59], v2, s[28:31], s86 offen offset:2048 nt
  buffer_load_dwordx4 v[60:63], v2, s[28:31], s86 offen offset:3072 nt
  v_add_f32_dpp v36, v34, v34 row_half_mirror row_mask:0xf bank_mask:0x5
  s_nop 1
  v_add_f32_dpp v36, v35, v35 row_half_mirror row_mask:0xf bank_mask:0xa
  s_nop 1
  v_add_f32_dpp v36, v36, v36 quad_perm:[1,0,3,2] row_mask:0xf bank_mask:0xf
  s_nop 1
  v_add_f32_dpp v36, v36, v36 quad_perm:[2,3,0,1] row_mask:0xf bank_mask:0xf
  v_cvt_pk_bf16_f32 v37, v36, v36
  v_and_b32 v37, 0xffff0000, v37
  v_mul_f32 v37, 0x3db504f3, v37
  v_cvt_pk_bf16_f32 v37, v37, v37
  v_and_b32 v37, 0xffff0000, v37
  v_mul_f32 v38, 0x3fb8aa3b, v37
  s_nop 1
  v_max_f32_dpp v39, v38, v38 row_ror:4 row_mask:0xf bank_mask:0xf
  s_nop 1
  v_max_f32_dpp v39, v39, v39 row_ror:8 row_mask:0xf bank_mask:0xf
  v_cmp_gt_f32 vcc, v39, v24
  s_cbranch_vccz L_nors_21
  v_max_f32 v39, v39, v24
  v_sub_f32 v43, v24, v39
  v_exp_f32 v43, v43
  v_mov_b32 v24, v39
  v_mul_f32 v25, v25, v43
  v_mul_f32 v16, v16, v43
  v_mul_f32 v17, v17, v43
  v_mul_f32 v18, v18, v43
  v_mul_f32 v19, v19, v43
  v_mul_f32 v20, v20, v43
  v_mul_f32 v21, v21, v43
  v_mul_f32 v22, v22, v43
  v_mul_f32 v23, v23, v43
L_nors_21:
  v_sub_f32 v40, v38, v24
  v_exp_f32 v40, v40
  s_nop 0
  v_cvt_pk_bf16_f32 v41, v40, 0
  v_add_f32 v25, v25, v40
  v_lshlrev_b32 v42, 16, v41
  s_waitcnt vmcnt(4)
  v_dot2c_f32_bf16_dpp v16, v41, v96 row_newbcast:0 row_mask:0xf bank_mask:0xf
  v_dot2c_f32_bf16_dpp v18, v41, v97 row_newbcast:0 row_mask:0xf bank_mask:0xf
  v_dot2c_f32_bf16_dpp v20, v41, v98 row_newbcast:0 row_mask:0xf bank_mask:0xf
  v_dot2c_f32_bf16_dpp v22, v41, v99 row_newbcast:0 row_mask:0xf bank_mask:0xf
  v_dot2c_f32_bf16_dpp v17, v42, v96 row_newbcast:0 row_mask:0xf bank_mask:0xf
  v_dot2c_f32_bf16_dpp v19, v42, v97 row_newbcast:0 row_mask:0xf bank_mask:0xf
  v_dot2c_f32_bf16_dpp v21, v42, v98 row_newbcast:0 row_mask:0xf bank_mask:0xf
  v_dot2c_f32_bf16_dpp v23, v42, v99 row_newbcast:0 row_mask:0xf bank_mask:0xf
  v_dot2c_f32_bf16_dpp v16, v41, v100 row_newbcast:8 row_mask:0xf bank_mask:0xf
  v_dot2c_f32_bf16_dpp v18, v41, v101 row_newbcast:8 row_mask:0xf bank_mask:0xf
  v_dot2c_f32_bf16_dpp v20, v41, v102 row_newbcast:8 row_mask:0xf bank_mask:0xf
  v_dot2c_f32_bf16_dpp v22, v41, v103 row_newbcast:8 row_mask:0xf bank_mask:0xf
  v_dot2c_f32_bf16_dpp v17, v42, v100 row_newbcast:8 row_mask:0xf bank_mask:0xf
  v_dot2c_f32_bf16_dpp v19, v42, v101 row_newbcast:8 row_mask:0xf bank_mask:0xf
  v_dot2c_f32_bf16_dpp v21, v42, v102 row_newbcast:8 row_mask:0xf bank_mask:0xf
  v_dot2c_f32_bf16_dpp v23, v42, v103 row_newbcast:8 row_mask:0xf bank_mask:0xf
  v_dot2c_f32_bf16_dpp v16, v41, v104 row_newbcast:4 row_mask:0xf bank_mask:0xf
  v_dot2c_f32_bf16_dpp v18, v41, v105 row_newbcast:4 row_mask:0xf bank_mask:0xf
  v_dot2c_f32_bf16_dpp v20, v41, v106 row_newbcast:4 row_mask:0xf bank_mask:0xf
  v_dot2c_f32_bf16_dpp v22, v41, v107 row_newbcast:4 row_mask:0xf bank_mask:0xf
  v_dot2c_f32_bf16_dpp v17, v42, v104 row_newbcast:4 row_mask:0xf bank_mask:0xf
  v_dot2c_f32_bf16_dpp v19, v42, v105 row_newbcast:4 row_mask:0xf bank_mask:0xf
  v_dot2c_f32_bf16_dpp v21, v42, v106 row_newbcast:4 row_mask:0xf bank_mask:0xf
  v_dot2c_f32_bf16_dpp v23, v42, v107 row_newbcast:4 row_mask:0xf bank_mask:0xf
  v_dot2c_f32_bf16_dpp v16, v41, v108 row_newbcast:12 row_mask:0xf bank_mask:0xf
  v_dot2c_f32_bf16_dpp v18, v41, v109 row_newbcast:12 row_mask:0xf bank_mask:0xf
  v_dot2c_f32_bf16_dpp v20, v41, v110 row_newbcast:12 row_mask:0xf bank_mask:0xf
  v_dot2c_f32_bf16_dpp v22, v41, v111 row_newbcast:12 row_mask:0xf bank_mask:0xf
  v_dot2c_f32_bf16_dpp v17, v42, v108 row_newbcast:12 row_mask:0xf bank_mask:0xf
  v_dot2c_f32_bf16_dpp v19, v42, v109 row_newbcast:12 row_mask:0xf bank_mask:0xf
  v_dot2c_f32_bf16_dpp v21, v42, v110 row_newbcast:12 row_mask:0xf bank_mask:0xf
  v_dot2c_f32_bf16_dpp v23, v42, v111 row_newbcast:12 row_mask:0xf bank_mask:0xf
  buffer_load_dwordx4 v[64:67], v2, s[32:35], s86 offen offset:0 nt
  buffer_load_dwordx4 v[68:71], v2, s[32:35], s86 offen offset:1024 nt
  buffer_load_dwordx4 v[72:75], v2, s[32:35], s86 offen offset:2048 nt
  buffer_load_dwordx4 v[76:79], v2, s[32:35], s86 offen offset:3072 nt
  v_mov_b32 v26, 1
  s_mov_b64 exec, 1
  buffer_atomic_add v26, v29, s[40:43], 0 offen sc0 sc1
  s_mov_b64 exec, -1
  s_waitcnt vmcnt(5)
  v_dot2_f32_bf16 v30, v48, v12, 0
  v_dot2_f32_bf16 v31, v52, v12, 0
  v_dot2_f32_bf16 v32, v56, v12, 0
  v_dot2_f32_bf16 v33, v60, v12, 0
  v_dot2_f32_bf16 v30, v49, v13, v30
  v_dot2_f32_bf16 v31, v53, v13, v31
  v_dot2_f32_bf16 v32, v57, v13, v32
  v_dot2_f32_bf16 v33, v61, v13, v33
  v_dot2_f32_bf16 v30, v50, v14, v30
  v_dot2_f32_bf16 v31, v54, v14, v31
  v_dot2_f32_bf16 v32, v58, v14, v32
  v_dot2_f32_bf16 v33, v62, v14, v33
  v_dot2_f32_bf16 v30, v51, v15, v30
  v_dot2_f32_bf16 v31, v55, v15, v31
  v_dot2_f32_bf16 v32, v59, v15, v32
  v_dot2_f32_bf16 v33, v63, v15, v33
  v_add_f32_dpp v34, v30, v30 row_ror:8 row_mask:0xf bank_mask:0x3
  s_nop 0
  v_add_f32_dpp v35, v32, v32 row_ror:8 row_mask:0xf bank_mask:0x3
  v_add_f32_dpp v34, v31, v31 row_ror:8 row_mask:0xf bank_mask:0xc
  s_nop 0
  v_add_f32_dpp v35, v33, v33 row_ror:8 row_mask:0xf bank_mask:0xc
  s_mov_b32 s87, s80
  s_add_u32 s80, s80, 32768
  buffer_load_dwordx4 v[80:83], v2, s[28:31], s87 offen offset:0 nt
  buffer_load_dwordx4 v[84:87], v2, s[28:31], s87 offen offset:1024 nt
  buffer_load_dwordx4 v[88:91], v2, s[28:31], s87 offen offset:2048 nt
  buffer_load_dwordx4 v[92:95], v2, s[28:31], s87 offen offset:3072 nt
  v_add_f32_dpp v36, v34, v34 row_half_mirror row_mask:0xf bank_mask:0x5
  s_nop 1
  v_add_f32_dpp v36, v35, v35 row_half_mirror row_mask:0xf bank_mask:0xa
  s_nop 1
  v_add_f32_dpp v36, v36, v36 quad_perm:[1,0,3,2] row_mask:0xf bank_mask:0xf
  s_nop 1
  v_add_f32_dpp v36, v36, v36 quad_perm:[2,3,0,1] row_mask:0xf bank_mask:0xf
  v_cvt_pk_bf16_f32 v37, v36, v36
  v_and_b32 v37, 0xffff0000, v37
  v_mul_f32 v37, 0x3db504f3, v37
  v_cvt_pk_bf16_f32 v37, v37, v37
  v_and_b32 v37, 0xffff0000, v37
  v_mul_f32 v38, 0x3fb8aa3b, v37
  s_nop 1
  v_max_f32_dpp v39, v38, v38 row_ror:4 row_mask:0xf bank_mask:0xf
  s_nop 1
  v_max_f32_dpp v39, v39, v39 row_ror:8 row_mask:0xf bank_mask:0xf
  v_cmp_gt_f32 vcc, v39, v24
  s_cbranch_vccz L_nors_22
  v_max_f32 v39, v39, v24
  v_sub_f32 v43, v24, v39
  v_exp_f32 v43, v43
  v_mov_b32 v24, v39
  v_mul_f32 v25, v25, v43
  v_mul_f32 v16, v16, v43
  v_mul_f32 v17, v17, v43
  v_mul_f32 v18, v18, v43
  v_mul_f32 v19, v19, v43
  v_mul_f32 v20, v20, v43
  v_mul_f32 v21, v21, v43
  v_mul_f32 v22, v22, v43
  v_mul_f32 v23, v23, v43
L_nors_22:
  v_sub_f32 v40, v38, v24
  v_exp_f32 v40, v40
  s_nop 0
  v_cvt_pk_bf16_f32 v41, v40, 0
  v_add_f32 v25, v25, v40
  v_lshlrev_b32 v42, 16, v41
  s_waitcnt vmcnt(5)
  v_dot2c_f32_bf16_dpp v16, v41, v64 row_newbcast:0 row_mask:0xf bank_mask:0xf
  v_dot2c_f32_bf16_dpp v18, v41, v65 row_newbcast:0 row_mask:0xf bank_mask:0xf
  v_dot2c_f32_bf16_dpp v20, v41, v66 row_newbcast:0 row_mask:0xf bank_mask:0xf
  v_dot2c_f32_bf16_dpp v22, v41, v67 row_newbcast:0 row_mask:0xf bank_mask:0xf
  v_dot2c_f32_bf16_dpp v17, v42, v64 row_newbcast:0 row_mask:0xf bank_mask:0xf
  v_dot2c_f32_bf16_dpp v19, v42, v65 row_newbcast:0 row_mask:0xf bank_mask:0xf
  v_dot2c_f32_bf16_dpp v21, v42, v66 row_newbcast:0 row_mask:0xf bank_mask:0xf
  v_dot2c_f32_bf16_dpp v23, v42, v67 row_newbcast:0 row_mask:0xf bank_mask:0xf
  v_dot2c_f32_bf16_dpp v16, v41, v68 row_newbcast:8 row_mask:0xf bank_mask:0xf
  v_dot2c_f32_bf16_dpp v18, v41, v69 row_newbcast:8 row_mask:0xf bank_mask:0xf
  v_dot2c_f32_bf16_dpp v20, v41, v70 row_newbcast:8 row_mask:0xf bank_mask:0xf
  v_dot2c_f32_bf16_dpp v22, v41, v71 row_newbcast:8 row_mask:0xf bank_mask:0xf
  v_dot2c_f32_bf16_dpp v17, v42, v68 row_newbcast:8 row_mask:0xf bank_mask:0xf
  v_dot2c_f32_bf16_dpp v19, v42, v69 row_newbcast:8 row_mask:0xf bank_mask:0xf
  v_dot2c_f32_bf16_dpp v21, v42, v70 row_newbcast:8 row_mask:0xf bank_mask:0xf
  v_dot2c_f32_bf16_dpp v23, v42, v71 row_newbcast:8 row_mask:0xf bank_mask:0xf
  v_dot2c_f32_bf16_dpp v16, v41, v72 row_newbcast:4 row_mask:0xf bank_mask:0xf
  v_dot2c_f32_bf16_dpp v18, v41, v73 row_newbcast:4 row_mask:0xf bank_mask:0xf
  v_dot2c_f32_bf16_dpp v20, v41, v74 row_newbcast:4 row_mask:0xf bank_mask:0xf
  v_dot2c_f32_bf16_dpp v22, v41, v75 row_newbcast:4 row_mask:0xf bank_mask:0xf
  v_dot2c_f32_bf16_dpp v17, v42, v72 row_newbcast:4 row_mask:0xf bank_mask:0xf
  v_dot2c_f32_bf16_dpp v19, v42, v73 row_newbcast:4 row_mask:0xf bank_mask:0xf
  v_dot2c_f32_bf16_dpp v21, v42, v74 row_newbcast:4 row_mask:0xf bank_mask:0xf
  v_dot2c_f32_bf16_dpp v23, v42, v75 row_newbcast:4 row_mask:0xf bank_mask:0xf
  v_dot2c_f32_bf16_dpp v16, v41, v76 row_newbcast:12 row_mask:0xf bank_mask:0xf
  v_dot2c_f32_bf16_dpp v18, v41, v77 row_newbcast:12 row_mask:0xf bank_mask:0xf
  v_dot2c_f32_bf16_dpp v20, v41, v78 row_newbcast:12 row_mask:0xf bank_mask:0xf
  v_dot2c_f32_bf16_dpp v22, v41, v79 row_newbcast:12 row_mask:0xf bank_mask:0xf
  v_dot2c_f32_bf16_dpp v17, v42, v76 row_newbcast:12 row_mask:0xf bank_mask:0xf
  v_dot2c_f32_bf16_dpp v19, v42, v77 row_newbcast:12 row_mask:0xf bank_mask:0xf
  v_dot2c_f32_bf16_dpp v21, v42, v78 row_newbcast:12 row_mask:0xf bank_mask:0xf
  v_dot2c_f32_bf16_dpp v23, v42, v79 row_newbcast:12 row_mask:0xf bank_mask:0xf
  buffer_load_dwordx4 v[96:99], v2, s[32:35], s87 offen offset:0 nt
  buffer_load_dwordx4 v[100:103], v2, s[32:35], s87 offen offset:1024 nt
  buffer_load_dwordx4 v[104:107], v2, s[32:35], s87 offen offset:2048 nt
  buffer_load_dwordx4 v[108:111], v2, s[32:35], s87 offen offset:3072 nt
  v_mov_b32 v27, 1
  s_mov_b64 exec, 1
  buffer_atomic_add v27, v29, s[40:43], 0 offen sc0 sc1
  s_mov_b64 exec, -1
  s_waitcnt vmcnt(5)
  v_dot2_f32_bf16 v30, v80, v12, 0
  v_dot2_f32_bf16 v31, v84, v12, 0
  v_dot2_f32_bf16 v32, v88, v12, 0
  v_dot2_f32_bf16 v33, v92, v12, 0
  v_dot2_f32_bf16 v30, v81, v13, v30
  v_dot2_f32_bf16 v31, v85, v13, v31
  v_dot2_f32_bf16 v32, v89, v13, v32
  v_dot2_f32_bf16 v33, v93, v13, v33
  v_dot2_f32_bf16 v30, v82, v14, v30
  v_dot2_f32_bf16 v31, v86, v14, v31
  v_dot2_f32_bf16 v32, v90, v14, v32
  v_dot2_f32_bf16 v33, v94, v14, v33
  v_dot2_f32_bf16 v30, v83, v15, v30
  v_dot2_f32_bf16 v31, v87, v15, v31
  v_dot2_f32_bf16 v32, v91, v15, v32
  v_dot2_f32_bf16 v33, v95, v15, v33
  v_add_f32_dpp v34, v30, v30 row_ror:8 row_mask:0xf bank_mask:0x3
  s_nop 0
  v_add_f32_dpp v35, v32, v32 row_ror:8 row_mask:0xf bank_mask:0x3
  v_add_f32_dpp v34, v31, v31 row_ror:8 row_mask:0xf bank_mask:0xc
  s_nop 0
  v_add_f32_dpp v35, v33, v33 row_ror:8 row_mask:0xf bank_mask:0xc
  v_readfirstlane_b32 s72, v26
  s_add_u32 s72, s72, 416
  s_cmp_ge_u32 s72, 512
  s_cbranch_scc1 L_drainT51
  s_lshl_b32 s86, s72, 12
  buffer_load_dwordx4 v[48:51], v2, s[28:31], s86 offen offset:0 nt
  buffer_load_dwordx4 v[52:55], v2, s[28:31], s86 offen offset:1024 nt
  buffer_load_dwordx4 v[56:59], v2, s[28:31], s86 offen offset:2048 nt
  buffer_load_dwordx4 v[60:63], v2, s[28:31], s86 offen offset:3072 nt
  v_add_f32_dpp v36, v34, v34 row_half_mirror row_mask:0xf bank_mask:0x5
  s_nop 1
  v_add_f32_dpp v36, v35, v35 row_half_mirror row_mask:0xf bank_mask:0xa
  s_nop 1
  v_add_f32_dpp v36, v36, v36 quad_perm:[1,0,3,2] row_mask:0xf bank_mask:0xf
  s_nop 1
  v_add_f32_dpp v36, v36, v36 quad_perm:[2,3,0,1] row_mask:0xf bank_mask:0xf
  v_cvt_pk_bf16_f32 v37, v36, v36
  v_and_b32 v37, 0xffff0000, v37
  v_mul_f32 v37, 0x3db504f3, v37
  v_cvt_pk_bf16_f32 v37, v37, v37
  v_and_b32 v37, 0xffff0000, v37
  v_mul_f32 v38, 0x3fb8aa3b, v37
  s_nop 1
  v_max_f32_dpp v39, v38, v38 row_ror:4 row_mask:0xf bank_mask:0xf
  s_nop 1
  v_max_f32_dpp v39, v39, v39 row_ror:8 row_mask:0xf bank_mask:0xf
  v_cmp_gt_f32 vcc, v39, v24
  s_cbranch_vccz L_nors_23
  v_max_f32 v39, v39, v24
  v_sub_f32 v43, v24, v39
  v_exp_f32 v43, v43
  v_mov_b32 v24, v39
  v_mul_f32 v25, v25, v43
  v_mul_f32 v16, v16, v43
  v_mul_f32 v17, v17, v43
  v_mul_f32 v18, v18, v43
  v_mul_f32 v19, v19, v43
  v_mul_f32 v20, v20, v43
  v_mul_f32 v21, v21, v43
  v_mul_f32 v22, v22, v43
  v_mul_f32 v23, v23, v43
L_nors_23:
  v_sub_f32 v40, v38, v24
  v_exp_f32 v40, v40
  s_nop 0
  v_cvt_pk_bf16_f32 v41, v40, 0
  v_add_f32 v25, v25, v40
  v_lshlrev_b32 v42, 16, v41
  s_waitcnt vmcnt(5)
  v_dot2c_f32_bf16_dpp v16, v41, v96 row_newbcast:0 row_mask:0xf bank_mask:0xf
  v_dot2c_f32_bf16_dpp v18, v41, v97 row_newbcast:0 row_mask:0xf bank_mask:0xf
  v_dot2c_f32_bf16_dpp v20, v41, v98 row_newbcast:0 row_mask:0xf bank_mask:0xf
  v_dot2c_f32_bf16_dpp v22, v41, v99 row_newbcast:0 row_mask:0xf bank_mask:0xf
  v_dot2c_f32_bf16_dpp v17, v42, v96 row_newbcast:0 row_mask:0xf bank_mask:0xf
  v_dot2c_f32_bf16_dpp v19, v42, v97 row_newbcast:0 row_mask:0xf bank_mask:0xf
  v_dot2c_f32_bf16_dpp v21, v42, v98 row_newbcast:0 row_mask:0xf bank_mask:0xf
  v_dot2c_f32_bf16_dpp v23, v42, v99 row_newbcast:0 row_mask:0xf bank_mask:0xf
  v_dot2c_f32_bf16_dpp v16, v41, v100 row_newbcast:8 row_mask:0xf bank_mask:0xf
  v_dot2c_f32_bf16_dpp v18, v41, v101 row_newbcast:8 row_mask:0xf bank_mask:0xf
  v_dot2c_f32_bf16_dpp v20, v41, v102 row_newbcast:8 row_mask:0xf bank_mask:0xf
  v_dot2c_f32_bf16_dpp v22, v41, v103 row_newbcast:8 row_mask:0xf bank_mask:0xf
  v_dot2c_f32_bf16_dpp v17, v42, v100 row_newbcast:8 row_mask:0xf bank_mask:0xf
  v_dot2c_f32_bf16_dpp v19, v42, v101 row_newbcast:8 row_mask:0xf bank_mask:0xf
  v_dot2c_f32_bf16_dpp v21, v42, v102 row_newbcast:8 row_mask:0xf bank_mask:0xf
  v_dot2c_f32_bf16_dpp v23, v42, v103 row_newbcast:8 row_mask:0xf bank_mask:0xf
  v_dot2c_f32_bf16_dpp v16, v41, v104 row_newbcast:4 row_mask:0xf bank_mask:0xf
  v_dot2c_f32_bf16_dpp v18, v41, v105 row_newbcast:4 row_mask:0xf bank_mask:0xf
  v_dot2c_f32_bf16_dpp v20, v41, v106 row_newbcast:4 row_mask:0xf bank_mask:0xf
  v_dot2c_f32_bf16_dpp v22, v41, v107 row_newbcast:4 row_mask:0xf bank_mask:0xf
  v_dot2c_f32_bf16_dpp v17, v42, v104 row_newbcast:4 row_mask:0xf bank_mask:0xf
  v_dot2c_f32_bf16_dpp v19, v42, v105 row_newbcast:4 row_mask:0xf bank_mask:0xf
  v_dot2c_f32_bf16_dpp v21, v42, v106 row_newbcast:4 row_mask:0xf bank_mask:0xf
  v_dot2c_f32_bf16_dpp v23, v42, v107 row_newbcast:4 row_mask:0xf bank_mask:0xf
  v_dot2c_f32_bf16_dpp v16, v41, v108 row_newbcast:12 row_mask:0xf bank_mask:0xf
  v_dot2c_f32_bf16_dpp v18, v41, v109 row_newbcast:12 row_mask:0xf bank_mask:0xf
  v_dot2c_f32_bf16_dpp v20, v41, v110 row_newbcast:12 row_mask:0xf bank_mask:0xf
  v_dot2c_f32_bf16_dpp v22, v41, v111 row_newbcast:12 row_mask:0xf bank_mask:0xf
  v_dot2c_f32_bf16_dpp v17, v42, v108 row_newbcast:12 row_mask:0xf bank_mask:0xf
  v_dot2c_f32_bf16_dpp v19, v42, v109 row_newbcast:12 row_mask:0xf bank_mask:0xf
  v_dot2c_f32_bf16_dpp v21, v42, v110 row_newbcast:12 row_mask:0xf bank_mask:0xf
  v_dot2c_f32_bf16_dpp v23, v42, v111 row_newbcast:12 row_mask:0xf bank_mask:0xf
  buffer_load_dwordx4 v[64:67], v2, s[32:35], s86 offen offset:0 nt
  buffer_load_dwordx4 v[68:71], v2, s[32:35], s86 offen offset:1024 nt
  buffer_load_dwordx4 v[72:75], v2, s[32:35], s86 offen offset:2048 nt
  buffer_load_dwordx4 v[76:79], v2, s[32:35], s86 offen offset:3072 nt
  v_mov_b32 v26, 1
  s_mov_b64 exec, 1
  buffer_atomic_add v26, v29, s[40:43], 0 offen sc0 sc1
  s_mov_b64 exec, -1
L_dyn:
  s_waitcnt vmcnt(5)
  v_dot2_f32_bf16 v30, v48, v12, 0
  v_dot2_f32_bf16 v31, v52, v12, 0
  v_dot2_f32_bf16 v32, v56, v12, 0
  v_dot2_f32_bf16 v33, v60, v12, 0
  v_dot2_f32_bf16 v30, v49, v13, v30
  v_dot2_f32_bf16 v31, v53, v13, v31
  v_dot2_f32_bf16 v32, v57, v13, v32
  v_dot2_f32_bf16 v33, v61, v13, v33
  v_dot2_f32_bf16 v30, v50, v14, v30
  v_dot2_f32_bf16 v31, v54, v14, v31
  v_dot2_f32_bf16 v32, v58, v14, v32
  v_dot2_f32_bf16 v33, v62, v14, v33
  v_dot2_f32_bf16 v30, v51, v15, v30
  v_dot2_f32_bf16 v31, v55, v15, v31
  v_dot2_f32_bf16 v32, v59, v15, v32
  v_dot2_f32_bf16 v33, v63, v15, v33
  v_add_f32_dpp v34, v30, v30 row_ror:8 row_mask:0xf bank_mask:0x3
  s_nop 0
  v_add_f32_dpp v35, v32, v32 row_ror:8 row_mask:0xf bank_mask:0x3
  v_add_f32_dpp v34, v31, v31 row_ror:8 row_mask:0xf bank_mask:0xc
  s_nop 0
  v_add_f32_dpp v35, v33, v33 row_ror:8 row_mask:0xf bank_mask:0xc
  v_readfirstlane_b32 s72, v27
  s_add_u32 s72, s72, 416
  s_cmp_ge_u32 s72, 512
  s_cbranch_scc1 L_drain0
  s_lshl_b32 s87, s72, 12
  buffer_load_dwordx4 v[80:83], v2, s[28:31], s87 offen offset:0 nt
  buffer_load_dwordx4 v[84:87], v2, s[28:31], s87 offen offset:1024 nt
  buffer_load_dwordx4 v[88:91], v2, s[28:31], s87 offen offset:2048 nt
  buffer_load_dwordx4 v[92:95], v2, s[28:31], s87 offen offset:3072 nt
  v_add_f32_dpp v36, v34, v34 row_half_mirror row_mask:0xf bank_mask:0x5
  s_nop 1
  v_add_f32_dpp v36, v35, v35 row_half_mirror row_mask:0xf bank_mask:0xa
  s_nop 1
  v_add_f32_dpp v36, v36, v36 quad_perm:[1,0,3,2] row_mask:0xf bank_mask:0xf
  s_nop 1
  v_add_f32_dpp v36, v36, v36 quad_perm:[2,3,0,1] row_mask:0xf bank_mask:0xf
  v_cvt_pk_bf16_f32 v37, v36, v36
  v_and_b32 v37, 0xffff0000, v37
  v_mul_f32 v37, 0x3db504f3, v37
  v_cvt_pk_bf16_f32 v37, v37, v37
  v_and_b32 v37, 0xffff0000, v37
  v_mul_f32 v38, 0x3fb8aa3b, v37
  s_nop 1
  v_max_f32_dpp v39, v38, v38 row_ror:4 row_mask:0xf bank_mask:0xf
  s_nop 1
  v_max_f32_dpp v39, v39, v39 row_ror:8 row_mask:0xf bank_mask:0xf
  v_cmp_gt_f32 vcc, v39, v24
  s_cbranch_vccz L_nors_24
  v_max_f32 v39, v39, v24
  v_sub_f32 v43, v24, v39
  v_exp_f32 v43, v43
  v_mov_b32 v24, v39
  v_mul_f32 v25, v25, v43
  v_mul_f32 v16, v16, v43
  v_mul_f32 v17, v17, v43
  v_mul_f32 v18, v18, v43
  v_mul_f32 v19, v19, v43
  v_mul_f32 v20, v20, v43
  v_mul_f32 v21, v21, v43
  v_mul_f32 v22, v22, v43
  v_mul_f32 v23, v23, v43
L_nors_24:
  v_sub_f32 v40, v38, v24
  v_exp_f32 v40, v40
  s_nop 0
  v_cvt_pk_bf16_f32 v41, v40, 0
  v_add_f32 v25, v25, v40
  v_lshlrev_b32 v42, 16, v41
  s_waitcnt vmcnt(5)
  v_dot2c_f32_bf16_dpp v16, v41, v64 row_newbcast:0 row_mask:0xf bank_mask:0xf
  v_dot2c_f32_bf16_dpp v18, v41, v65 row_newbcast:0 row_mask:0xf bank_mask:0xf
  v_dot2c_f32_bf16_dpp v20, v41, v66 row_newbcast:0 row_mask:0xf bank_mask:0xf
  v_dot2c_f32_bf16_dpp v22, v41, v67 row_newbcast:0 row_mask:0xf bank_mask:0xf
  v_dot2c_f32_bf16_dpp v17, v42, v64 row_newbcast:0 row_mask:0xf bank_mask:0xf
  v_dot2c_f32_bf16_dpp v19, v42, v65 row_newbcast:0 row_mask:0xf bank_mask:0xf
  v_dot2c_f32_bf16_dpp v21, v42, v66 row_newbcast:0 row_mask:0xf bank_mask:0xf
  v_dot2c_f32_bf16_dpp v23, v42, v67 row_newbcast:0 row_mask:0xf bank_mask:0xf
  v_dot2c_f32_bf16_dpp v16, v41, v68 row_newbcast:8 row_mask:0xf bank_mask:0xf
  v_dot2c_f32_bf16_dpp v18, v41, v69 row_newbcast:8 row_mask:0xf bank_mask:0xf
  v_dot2c_f32_bf16_dpp v20, v41, v70 row_newbcast:8 row_mask:0xf bank_mask:0xf
  v_dot2c_f32_bf16_dpp v22, v41, v71 row_newbcast:8 row_mask:0xf bank_mask:0xf
  v_dot2c_f32_bf16_dpp v17, v42, v68 row_newbcast:8 row_mask:0xf bank_mask:0xf
  v_dot2c_f32_bf16_dpp v19, v42, v69 row_newbcast:8 row_mask:0xf bank_mask:0xf
  v_dot2c_f32_bf16_dpp v21, v42, v70 row_newbcast:8 row_mask:0xf bank_mask:0xf
  v_dot2c_f32_bf16_dpp v23, v42, v71 row_newbcast:8 row_mask:0xf bank_mask:0xf
  v_dot2c_f32_bf16_dpp v16, v41, v72 row_newbcast:4 row_mask:0xf bank_mask:0xf
  v_dot2c_f32_bf16_dpp v18, v41, v73 row_newbcast:4 row_mask:0xf bank_mask:0xf
  v_dot2c_f32_bf16_dpp v20, v41, v74 row_newbcast:4 row_mask:0xf bank_mask:0xf
  v_dot2c_f32_bf16_dpp v22, v41, v75 row_newbcast:4 row_mask:0xf bank_mask:0xf
  v_dot2c_f32_bf16_dpp v17, v42, v72 row_newbcast:4 row_mask:0xf bank_mask:0xf
  v_dot2c_f32_bf16_dpp v19, v42, v73 row_newbcast:4 row_mask:0xf bank_mask:0xf
  v_dot2c_f32_bf16_dpp v21, v42, v74 row_newbcast:4 row_mask:0xf bank_mask:0xf
  v_dot2c_f32_bf16_dpp v23, v42, v75 row_newbcast:4 row_mask:0xf bank_mask:0xf
  v_dot2c_f32_bf16_dpp v16, v41, v76 row_newbcast:12 row_mask:0xf bank_mask:0xf
  v_dot2c_f32_bf16_dpp v18, v41, v77 row_newbcast:12 row_mask:0xf bank_mask:0xf
  v_dot2c_f32_bf16_dpp v20, v41, v78 row_newbcast:12 row_mask:0xf bank_mask:0xf
  v_dot2c_f32_bf16_dpp v22, v41, v79 row_newbcast:12 row_mask:0xf bank_mask:0xf
  v_dot2c_f32_bf16_dpp v17, v42, v76 row_newbcast:12 row_mask:0xf bank_mask:0xf
  v_dot2c_f32_bf16_dpp v19, v42, v77 row_newbcast:12 row_mask:0xf bank_mask:0xf
  v_dot2c_f32_bf16_dpp v21, v42, v78 row_newbcast:12 row_mask:0xf bank_mask:0xf
  v_dot2c_f32_bf16_dpp v23, v42, v79 row_newbcast:12 row_mask:0xf bank_mask:0xf
  buffer_load_dwordx4 v[96:99], v2, s[32:35], s87 offen offset:0 nt
  buffer_load_dwordx4 v[100:103], v2, s[32:35], s87 offen offset:1024 nt
  buffer_load_dwordx4 v[104:107], v2, s[32:35], s87 offen offset:2048 nt
  buffer_load_dwordx4 v[108:111], v2, s[32:35], s87 offen offset:3072 nt
  v_mov_b32 v27, 1
  s_mov_b64 exec, 1
  buffer_atomic_add v27, v29, s[40:43], 0 offen sc0 sc1
  s_mov_b64 exec, -1
  s_waitcnt vmcnt(5)
  v_dot2_f32_bf16 v30, v80, v12, 0
  v_dot2_f32_bf16 v31, v84, v12, 0
  v_dot2_f32_bf16 v32, v88, v12, 0
  v_dot2_f32_bf16 v33, v92, v12, 0
  v_dot2_f32_bf16 v30, v81, v13, v30
  v_dot2_f32_bf16 v31, v85, v13, v31
  v_dot2_f32_bf16 v32, v89, v13, v32
  v_dot2_f32_bf16 v33, v93, v13, v33
  v_dot2_f32_bf16 v30, v82, v14, v30
  v_dot2_f32_bf16 v31, v86, v14, v31
  v_dot2_f32_bf16 v32, v90, v14, v32
  v_dot2_f32_bf16 v33, v94, v14, v33
  v_dot2_f32_bf16 v30, v83, v15, v30
  v_dot2_f32_bf16 v31, v87, v15, v31
  v_dot2_f32_bf16 v32, v91, v15, v32
  v_dot2_f32_bf16 v33, v95, v15, v33
  v_add_f32_dpp v34, v30, v30 row_ror:8 row_mask:0xf bank_mask:0x3
  s_nop 0
  v_add_f32_dpp v35, v32, v32 row_ror:8 row_mask:0xf bank_mask:0x3
  v_add_f32_dpp v34, v31, v31 row_ror:8 row_mask:0xf bank_mask:0xc
  s_nop 0
  v_add_f32_dpp v35, v33, v33 row_ror:8 row_mask:0xf bank_mask:0xc
  v_readfirstlane_b32 s72, v26
  s_add_u32 s72, s72, 416
  s_cmp_ge_u32 s72, 512
  s_cbranch_scc1 L_drain1
  s_lshl_b32 s86, s72, 12
  buffer_load_dwordx4 v[48:51], v2, s[28:31], s86 offen offset:0 nt
  buffer_load_dwordx4 v[52:55], v2, s[28:31], s86 offen offset:1024 nt
  buffer_load_dwordx4 v[56:59], v2, s[28:31], s86 offen offset:2048 nt
  buffer_load_dwordx4 v[60:63], v2, s[28:31], s86 offen offset:3072 nt
  v_add_f32_dpp v36, v34, v34 row_half_mirror row_mask:0xf bank_mask:0x5
  s_nop 1
  v_add_f32_dpp v36, v35, v35 row_half_mirror row_mask:0xf bank_mask:0xa
  s_nop 1
  v_add_f32_dpp v36, v36, v36 quad_perm:[1,0,3,2] row_mask:0xf bank_mask:0xf
  s_nop 1
  v_add_f32_dpp v36, v36, v36 quad_perm:[2,3,0,1] row_mask:0xf bank_mask:0xf
  v_cvt_pk_bf16_f32 v37, v36, v36
  v_and_b32 v37, 0xffff0000, v37
  v_mul_f32 v37, 0x3db504f3, v37
  v_cvt_pk_bf16_f32 v37, v37, v37
  v_and_b32 v37, 0xffff0000, v37
  v_mul_f32 v38, 0x3fb8aa3b, v37
  s_nop 1
  v_max_f32_dpp v39, v38, v38 row_ror:4 row_mask:0xf bank_mask:0xf
  s_nop 1
  v_max_f32_dpp v39, v39, v39 row_ror:8 row_mask:0xf bank_mask:0xf
  v_cmp_gt_f32 vcc, v39, v24
  s_cbranch_vccz L_nors_25
  v_max_f32 v39, v39, v24
  v_sub_f32 v43, v24, v39
  v_exp_f32 v43, v43
  v_mov_b32 v24, v39
  v_mul_f32 v25, v25, v43
  v_mul_f32 v16, v16, v43
  v_mul_f32 v17, v17, v43
  v_mul_f32 v18, v18, v43
  v_mul_f32 v19, v19, v43
  v_mul_f32 v20, v20, v43
  v_mul_f32 v21, v21, v43
  v_mul_f32 v22, v22, v43
  v_mul_f32 v23, v23, v43
L_nors_25:
  v_sub_f32 v40, v38, v24
  v_exp_f32 v40, v40
  s_nop 0
  v_cvt_pk_bf16_f32 v41, v40, 0
  v_add_f32 v25, v25, v40
  v_lshlrev_b32 v42, 16, v41
  s_waitcnt vmcnt(5)
  v_dot2c_f32_bf16_dpp v16, v41, v96 row_newbcast:0 row_mask:0xf bank_mask:0xf
  v_dot2c_f32_bf16_dpp v18, v41, v97 row_newbcast:0 row_mask:0xf bank_mask:0xf
  v_dot2c_f32_bf16_dpp v20, v41, v98 row_newbcast:0 row_mask:0xf bank_mask:0xf
  v_dot2c_f32_bf16_dpp v22, v41, v99 row_newbcast:0 row_mask:0xf bank_mask:0xf
  v_dot2c_f32_bf16_dpp v17, v42, v96 row_newbcast:0 row_mask:0xf bank_mask:0xf
  v_dot2c_f32_bf16_dpp v19, v42, v97 row_newbcast:0 row_mask:0xf bank_mask:0xf
  v_dot2c_f32_bf16_dpp v21, v42, v98 row_newbcast:0 row_mask:0xf bank_mask:0xf
  v_dot2c_f32_bf16_dpp v23, v42, v99 row_newbcast:0 row_mask:0xf bank_mask:0xf
  v_dot2c_f32_bf16_dpp v16, v41, v100 row_newbcast:8 row_mask:0xf bank_mask:0xf
  v_dot2c_f32_bf16_dpp v18, v41, v101 row_newbcast:8 row_mask:0xf bank_mask:0xf
  v_dot2c_f32_bf16_dpp v20, v41, v102 row_newbcast:8 row_mask:0xf bank_mask:0xf
  v_dot2c_f32_bf16_dpp v22, v41, v103 row_newbcast:8 row_mask:0xf bank_mask:0xf
  v_dot2c_f32_bf16_dpp v17, v42, v100 row_newbcast:8 row_mask:0xf bank_mask:0xf
  v_dot2c_f32_bf16_dpp v19, v42, v101 row_newbcast:8 row_mask:0xf bank_mask:0xf
  v_dot2c_f32_bf16_dpp v21, v42, v102 row_newbcast:8 row_mask:0xf bank_mask:0xf
  v_dot2c_f32_bf16_dpp v23, v42, v103 row_newbcast:8 row_mask:0xf bank_mask:0xf
  v_dot2c_f32_bf16_dpp v16, v41, v104 row_newbcast:4 row_mask:0xf bank_mask:0xf
  v_dot2c_f32_bf16_dpp v18, v41, v105 row_newbcast:4 row_mask:0xf bank_mask:0xf
  v_dot2c_f32_bf16_dpp v20, v41, v106 row_newbcast:4 row_mask:0xf bank_mask:0xf
  v_dot2c_f32_bf16_dpp v22, v41, v107 row_newbcast:4 row_mask:0xf bank_mask:0xf
  v_dot2c_f32_bf16_dpp v17, v42, v104 row_newbcast:4 row_mask:0xf bank_mask:0xf
  v_dot2c_f32_bf16_dpp v19, v42, v105 row_newbcast:4 row_mask:0xf bank_mask:0xf
  v_dot2c_f32_bf16_dpp v21, v42, v106 row_newbcast:4 row_mask:0xf bank_mask:0xf
  v_dot2c_f32_bf16_dpp v23, v42, v107 row_newbcast:4 row_mask:0xf bank_mask:0xf
  v_dot2c_f32_bf16_dpp v16, v41, v108 row_newbcast:12 row_mask:0xf bank_mask:0xf
  v_dot2c_f32_bf16_dpp v18, v41, v109 row_newbcast:12 row_mask:0xf bank_mask:0xf
  v_dot2c_f32_bf16_dpp v20, v41, v110 row_newbcast:12 row_mask:0xf bank_mask:0xf
  v_dot2c_f32_bf16_dpp v22, v41, v111 row_newbcast:12 row_mask:0xf bank_mask:0xf
  v_dot2c_f32_bf16_dpp v17, v42, v108 row_newbcast:12 row_mask:0xf bank_mask:0xf
  v_dot2c_f32_bf16_dpp v19, v42, v109 row_newbcast:12 row_mask:0xf bank_mask:0xf
  v_dot2c_f32_bf16_dpp v21, v42, v110 row_newbcast:12 row_mask:0xf bank_mask:0xf
  v_dot2c_f32_bf16_dpp v23, v42, v111 row_newbcast:12 row_mask:0xf bank_mask:0xf
  buffer_load_dwordx4 v[64:67], v2, s[32:35], s86 offen offset:0 nt
  buffer_load_dwordx4 v[68:71], v2, s[32:35], s86 offen offset:1024 nt
  buffer_load_dwordx4 v[72:75], v2, s[32:35], s86 offen offset:2048 nt
  buffer_load_dwordx4 v[76:79], v2, s[32:35], s86 offen offset:3072 nt
  v_mov_b32 v26, 1
  s_mov_b64 exec, 1
  buffer_atomic_add v26, v29, s[40:43], 0 offen sc0 sc1
  s_mov_b64 exec, -1
  s_branch L_dyn
L_drainT51:
  v_add_f32_dpp v36, v34, v34 row_half_mirror row_mask:0xf bank_mask:0x5
  s_nop 1
  v_add_f32_dpp v36, v35, v35 row_half_mirror row_mask:0xf bank_mask:0xa
  s_nop 1
  v_add_f32_dpp v36, v36, v36 quad_perm:[1,0,3,2] row_mask:0xf bank_mask:0xf
  s_nop 1
  v_add_f32_dpp v36, v36, v36 quad_perm:[2,3,0,1] row_mask:0xf bank_mask:0xf
  v_cvt_pk_bf16_f32 v37, v36, v36
  v_and_b32 v37, 0xffff0000, v37
  v_mul_f32 v37, 0x3db504f3, v37
  v_cvt_pk_bf16_f32 v37, v37, v37
  v_and_b32 v37, 0xffff0000, v37
  v_mul_f32 v38, 0x3fb8aa3b, v37
  s_nop 1
  v_max_f32_dpp v39, v38, v38 row_ror:4 row_mask:0xf bank_mask:0xf
  s_nop 1
  v_max_f32_dpp v39, v39, v39 row_ror:8 row_mask:0xf bank_mask:0xf
  v_cmp_gt_f32 vcc, v39, v24
  s_cbranch_vccz L_nors_26
  v_max_f32 v39, v39, v24
  v_sub_f32 v43, v24, v39
  v_exp_f32 v43, v43
  v_mov_b32 v24, v39
  v_mul_f32 v25, v25, v43
  v_mul_f32 v16, v16, v43
  v_mul_f32 v17, v17, v43
  v_mul_f32 v18, v18, v43
  v_mul_f32 v19, v19, v43
  v_mul_f32 v20, v20, v43
  v_mul_f32 v21, v21, v43
  v_mul_f32 v22, v22, v43
  v_mul_f32 v23, v23, v43
L_nors_26:
  v_sub_f32 v40, v38, v24
  v_exp_f32 v40, v40
  s_nop 0
  v_cvt_pk_bf16_f32 v41, v40, 0
  v_add_f32 v25, v25, v40
  v_lshlrev_b32 v42, 16, v41
  s_waitcnt vmcnt(1)
  v_dot2c_f32_bf16_dpp v16, v41, v96 row_newbcast:0 row_mask:0xf bank_mask:0xf
  v_dot2c_f32_bf16_dpp v18, v41, v97 row_newbcast:0 row_mask:0xf bank_mask:0xf
  v_dot2c_f32_bf16_dpp v20, v41, v98 row_newbcast:0 row_mask:0xf bank_mask:0xf
  v_dot2c_f32_bf16_dpp v22, v41, v99 row_newbcast:0 row_mask:0xf bank_mask:0xf
  v_dot2c_f32_bf16_dpp v17, v42, v96 row_newbcast:0 row_mask:0xf bank_mask:0xf
  v_dot2c_f32_bf16_dpp v19, v42, v97 row_newbcast:0 row_mask:0xf bank_mask:0xf
  v_dot2c_f32_bf16_dpp v21, v42, v98 row_newbcast:0 row_mask:0xf bank_mask:0xf
  v_dot2c_f32_bf16_dpp v23, v42, v99 row_newbcast:0 row_mask:0xf bank_mask:0xf
  v_dot2c_f32_bf16_dpp v16, v41, v100 row_newbcast:8 row_mask:0xf bank_mask:0xf
  v_dot2c_f32_bf16_dpp v18, v41, v101 row_newbcast:8 row_mask:0xf bank_mask:0xf
  v_dot2c_f32_bf16_dpp v20, v41, v102 row_newbcast:8 row_mask:0xf bank_mask:0xf
  v_dot2c_f32_bf16_dpp v22, v41, v103 row_newbcast:8 row_mask:0xf bank_mask:0xf
  v_dot2c_f32_bf16_dpp v17, v42, v100 row_newbcast:8 row_mask:0xf bank_mask:0xf
  v_dot2c_f32_bf16_dpp v19, v42, v101 row_newbcast:8 row_mask:0xf bank_mask:0xf
  v_dot2c_f32_bf16_dpp v21, v42, v102 row_newbcast:8 row_mask:0xf bank_mask:0xf
  v_dot2c_f32_bf16_dpp v23, v42, v103 row_newbcast:8 row_mask:0xf bank_mask:0xf
  v_dot2c_f32_bf16_dpp v16, v41, v104 row_newbcast:4 row_mask:0xf bank_mask:0xf
  v_dot2c_f32_bf16_dpp v18, v41, v105 row_newbcast:4 row_mask:0xf bank_mask:0xf
  v_dot2c_f32_bf16_dpp v20, v41, v106 row_newbcast:4 row_mask:0xf bank_mask:0xf
  v_dot2c_f32_bf16_dpp v22, v41, v107 row_newbcast:4 row_mask:0xf bank_mask:0xf
  v_dot2c_f32_bf16_dpp v17, v42, v104 row_newbcast:4 row_mask:0xf bank_mask:0xf
  v_dot2c_f32_bf16_dpp v19, v42, v105 row_newbcast:4 row_mask:0xf bank_mask:0xf
  v_dot2c_f32_bf16_dpp v21, v42, v106 row_newbcast:4 row_mask:0xf bank_mask:0xf
  v_dot2c_f32_bf16_dpp v23, v42, v107 row_newbcast:4 row_mask:0xf bank_mask:0xf
  v_dot2c_f32_bf16_dpp v16, v41, v108 row_newbcast:12 row_mask:0xf bank_mask:0xf
  v_dot2c_f32_bf16_dpp v18, v41, v109 row_newbcast:12 row_mask:0xf bank_mask:0xf
  v_dot2c_f32_bf16_dpp v20, v41, v110 row_newbcast:12 row_mask:0xf bank_mask:0xf
  v_dot2c_f32_bf16_dpp v22, v41, v111 row_newbcast:12 row_mask:0xf bank_mask:0xf
  v_dot2c_f32_bf16_dpp v17, v42, v108 row_newbcast:12 row_mask:0xf bank_mask:0xf
  v_dot2c_f32_bf16_dpp v19, v42, v109 row_newbcast:12 row_mask:0xf bank_mask:0xf
  v_dot2c_f32_bf16_dpp v21, v42, v110 row_newbcast:12 row_mask:0xf bank_mask:0xf
  v_dot2c_f32_bf16_dpp v23, v42, v111 row_newbcast:12 row_mask:0xf bank_mask:0xf
  s_branch L_merge
L_drain0:
  v_add_f32_dpp v36, v34, v34 row_half_mirror row_mask:0xf bank_mask:0x5
  s_nop 1
  v_add_f32_dpp v36, v35, v35 row_half_mirror row_mask:0xf bank_mask:0xa
  s_nop 1
  v_add_f32_dpp v36, v36, v36 quad_perm:[1,0,3,2] row_mask:0xf bank_mask:0xf
  s_nop 1
  v_add_f32_dpp v36, v36, v36 quad_perm:[2,3,0,1] row_mask:0xf bank_mask:0xf
  v_cvt_pk_bf16_f32 v37, v36, v36
  v_and_b32 v37, 0xffff0000, v37
  v_mul_f32 v37, 0x3db504f3, v37
  v_cvt_pk_bf16_f32 v37, v37, v37
  v_and_b32 v37, 0xffff0000, v37
  v_mul_f32 v38, 0x3fb8aa3b, v37
  s_nop 1
  v_max_f32_dpp v39, v38, v38 row_ror:4 row_mask:0xf bank_mask:0xf
  s_nop 1
  v_max_f32_dpp v39, v39, v39 row_ror:8 row_mask:0xf bank_mask:0xf
  v_cmp_gt_f32 vcc, v39, v24
  s_cbranch_vccz L_nors_27
  v_max_f32 v39, v39, v24
  v_sub_f32 v43, v24, v39
  v_exp_f32 v43, v43
  v_mov_b32 v24, v39
  v_mul_f32 v25, v25, v43
  v_mul_f32 v16, v16, v43
  v_mul_f32 v17, v17, v43
  v_mul_f32 v18, v18, v43
  v_mul_f32 v19, v19, v43
  v_mul_f32 v20, v20, v43
  v_mul_f32 v21, v21, v43
  v_mul_f32 v22, v22, v43
  v_mul_f32 v23, v23, v43
L_nors_27:
  v_sub_f32 v40, v38, v24
  v_exp_f32 v40, v40
  s_nop 0
  v_cvt_pk_bf16_f32 v41, v40, 0
  v_add_f32 v25, v25, v40
  v_lshlrev_b32 v42, 16, v41
  s_waitcnt vmcnt(1)
  v_dot2c_f32_bf16_dpp v16, v41, v64 row_newbcast:0 row_mask:0xf bank_mask:0xf
  v_dot2c_f32_bf16_dpp v18, v41, v65 row_newbcast:0 row_mask:0xf bank_mask:0xf
  v_dot2c_f32_bf16_dpp v20, v41, v66 row_newbcast:0 row_mask:0xf bank_mask:0xf
  v_dot2c_f32_bf16_dpp v22, v41, v67 row_newbcast:0 row_mask:0xf bank_mask:0xf
  v_dot2c_f32_bf16_dpp v17, v42, v64 row_newbcast:0 row_mask:0xf bank_mask:0xf
  v_dot2c_f32_bf16_dpp v19, v42, v65 row_newbcast:0 row_mask:0xf bank_mask:0xf
  v_dot2c_f32_bf16_dpp v21, v42, v66 row_newbcast:0 row_mask:0xf bank_mask:0xf
  v_dot2c_f32_bf16_dpp v23, v42, v67 row_newbcast:0 row_mask:0xf bank_mask:0xf
  v_dot2c_f32_bf16_dpp v16, v41, v68 row_newbcast:8 row_mask:0xf bank_mask:0xf
  v_dot2c_f32_bf16_dpp v18, v41, v69 row_newbcast:8 row_mask:0xf bank_mask:0xf
  v_dot2c_f32_bf16_dpp v20, v41, v70 row_newbcast:8 row_mask:0xf bank_mask:0xf
  v_dot2c_f32_bf16_dpp v22, v41, v71 row_newbcast:8 row_mask:0xf bank_mask:0xf
  v_dot2c_f32_bf16_dpp v17, v42, v68 row_newbcast:8 row_mask:0xf bank_mask:0xf
  v_dot2c_f32_bf16_dpp v19, v42, v69 row_newbcast:8 row_mask:0xf bank_mask:0xf
  v_dot2c_f32_bf16_dpp v21, v42, v70 row_newbcast:8 row_mask:0xf bank_mask:0xf
  v_dot2c_f32_bf16_dpp v23, v42, v71 row_newbcast:8 row_mask:0xf bank_mask:0xf
  v_dot2c_f32_bf16_dpp v16, v41, v72 row_newbcast:4 row_mask:0xf bank_mask:0xf
  v_dot2c_f32_bf16_dpp v18, v41, v73 row_newbcast:4 row_mask:0xf bank_mask:0xf
  v_dot2c_f32_bf16_dpp v20, v41, v74 row_newbcast:4 row_mask:0xf bank_mask:0xf
  v_dot2c_f32_bf16_dpp v22, v41, v75 row_newbcast:4 row_mask:0xf bank_mask:0xf
  v_dot2c_f32_bf16_dpp v17, v42, v72 row_newbcast:4 row_mask:0xf bank_mask:0xf
  v_dot2c_f32_bf16_dpp v19, v42, v73 row_newbcast:4 row_mask:0xf bank_mask:0xf
  v_dot2c_f32_bf16_dpp v21, v42, v74 row_newbcast:4 row_mask:0xf bank_mask:0xf
  v_dot2c_f32_bf16_dpp v23, v42, v75 row_newbcast:4 row_mask:0xf bank_mask:0xf
  v_dot2c_f32_bf16_dpp v16, v41, v76 row_newbcast:12 row_mask:0xf bank_mask:0xf
  v_dot2c_f32_bf16_dpp v18, v41, v77 row_newbcast:12 row_mask:0xf bank_mask:0xf
  v_dot2c_f32_bf16_dpp v20, v41, v78 row_newbcast:12 row_mask:0xf bank_mask:0xf
  v_dot2c_f32_bf16_dpp v22, v41, v79 row_newbcast:12 row_mask:0xf bank_mask:0xf
  v_dot2c_f32_bf16_dpp v17, v42, v76 row_newbcast:12 row_mask:0xf bank_mask:0xf
  v_dot2c_f32_bf16_dpp v19, v42, v77 row_newbcast:12 row_mask:0xf bank_mask:0xf
  v_dot2c_f32_bf16_dpp v21, v42, v78 row_newbcast:12 row_mask:0xf bank_mask:0xf
  v_dot2c_f32_bf16_dpp v23, v42, v79 row_newbcast:12 row_mask:0xf bank_mask:0xf
  s_branch L_merge
L_drain1:
  v_add_f32_dpp v36, v34, v34 row_half_mirror row_mask:0xf bank_mask:0x5
  s_nop 1
  v_add_f32_dpp v36, v35, v35 row_half_mirror row_mask:0xf bank_mask:0xa
  s_nop 1
  v_add_f32_dpp v36, v36, v36 quad_perm:[1,0,3,2] row_mask:0xf bank_mask:0xf
  s_nop 1
  v_add_f32_dpp v36, v36, v36 quad_perm:[2,3,0,1] row_mask:0xf bank_mask:0xf
  v_cvt_pk_bf16_f32 v37, v36, v36
  v_and_b32 v37, 0xffff0000, v37
  v_mul_f32 v37, 0x3db504f3, v37
  v_cvt_pk_bf16_f32 v37, v37, v37
  v_and_b32 v37, 0xffff0000, v37
  v_mul_f32 v38, 0x3fb8aa3b, v37
  s_nop 1
  v_max_f32_dpp v39, v38, v38 row_ror:4 row_mask:0xf bank_mask:0xf
  s_nop 1
  v_max_f32_dpp v39, v39, v39 row_ror:8 row_mask:0xf bank_mask:0xf
  v_cmp_gt_f32 vcc, v39, v24
  s_cbranch_vccz L_nors_28
  v_max_f32 v39, v39, v24
  v_sub_f32 v43, v24, v39
  v_exp_f32 v43, v43
  v_mov_b32 v24, v39
  v_mul_f32 v25, v25, v43
  v_mul_f32 v16, v16, v43
  v_mul_f32 v17, v17, v43
  v_mul_f32 v18, v18, v43
  v_mul_f32 v19, v19, v43
  v_mul_f32 v20, v20, v43
  v_mul_f32 v21, v21, v43
  v_mul_f32 v22, v22, v43
  v_mul_f32 v23, v23, v43
L_nors_28:
  v_sub_f32 v40, v38, v24
  v_exp_f32 v40, v40
  s_nop 0
  v_cvt_pk_bf16_f32 v41, v40, 0
  v_add_f32 v25, v25, v40
  v_lshlrev_b32 v42, 16, v41
  s_waitcnt vmcnt(1)
  v_dot2c_f32_bf16_dpp v16, v41, v96 row_newbcast:0 row_mask:0xf bank_mask:0xf
  v_dot2c_f32_bf16_dpp v18, v41, v97 row_newbcast:0 row_mask:0xf bank_mask:0xf
  v_dot2c_f32_bf16_dpp v20, v41, v98 row_newbcast:0 row_mask:0xf bank_mask:0xf
  v_dot2c_f32_bf16_dpp v22, v41, v99 row_newbcast:0 row_mask:0xf bank_mask:0xf
  v_dot2c_f32_bf16_dpp v17, v42, v96 row_newbcast:0 row_mask:0xf bank_mask:0xf
  v_dot2c_f32_bf16_dpp v19, v42, v97 row_newbcast:0 row_mask:0xf bank_mask:0xf
  v_dot2c_f32_bf16_dpp v21, v42, v98 row_newbcast:0 row_mask:0xf bank_mask:0xf
  v_dot2c_f32_bf16_dpp v23, v42, v99 row_newbcast:0 row_mask:0xf bank_mask:0xf
  v_dot2c_f32_bf16_dpp v16, v41, v100 row_newbcast:8 row_mask:0xf bank_mask:0xf
  v_dot2c_f32_bf16_dpp v18, v41, v101 row_newbcast:8 row_mask:0xf bank_mask:0xf
  v_dot2c_f32_bf16_dpp v20, v41, v102 row_newbcast:8 row_mask:0xf bank_mask:0xf
  v_dot2c_f32_bf16_dpp v22, v41, v103 row_newbcast:8 row_mask:0xf bank_mask:0xf
  v_dot2c_f32_bf16_dpp v17, v42, v100 row_newbcast:8 row_mask:0xf bank_mask:0xf
  v_dot2c_f32_bf16_dpp v19, v42, v101 row_newbcast:8 row_mask:0xf bank_mask:0xf
  v_dot2c_f32_bf16_dpp v21, v42, v102 row_newbcast:8 row_mask:0xf bank_mask:0xf
  v_dot2c_f32_bf16_dpp v23, v42, v103 row_newbcast:8 row_mask:0xf bank_mask:0xf
  v_dot2c_f32_bf16_dpp v16, v41, v104 row_newbcast:4 row_mask:0xf bank_mask:0xf
  v_dot2c_f32_bf16_dpp v18, v41, v105 row_newbcast:4 row_mask:0xf bank_mask:0xf
  v_dot2c_f32_bf16_dpp v20, v41, v106 row_newbcast:4 row_mask:0xf bank_mask:0xf
  v_dot2c_f32_bf16_dpp v22, v41, v107 row_newbcast:4 row_mask:0xf bank_mask:0xf
  v_dot2c_f32_bf16_dpp v17, v42, v104 row_newbcast:4 row_mask:0xf bank_mask:0xf
  v_dot2c_f32_bf16_dpp v19, v42, v105 row_newbcast:4 row_mask:0xf bank_mask:0xf
  v_dot2c_f32_bf16_dpp v21, v42, v106 row_newbcast:4 row_mask:0xf bank_mask:0xf
  v_dot2c_f32_bf16_dpp v23, v42, v107 row_newbcast:4 row_mask:0xf bank_mask:0xf
  v_dot2c_f32_bf16_dpp v16, v41, v108 row_newbcast:12 row_mask:0xf bank_mask:0xf
  v_dot2c_f32_bf16_dpp v18, v41, v109 row_newbcast:12 row_mask:0xf bank_mask:0xf
  v_dot2c_f32_bf16_dpp v20, v41, v110 row_newbcast:12 row_mask:0xf bank_mask:0xf
  v_dot2c_f32_bf16_dpp v22, v41, v111 row_newbcast:12 row_mask:0xf bank_mask:0xf
  v_dot2c_f32_bf16_dpp v17, v42, v108 row_newbcast:12 row_mask:0xf bank_mask:0xf
  v_dot2c_f32_bf16_dpp v19, v42, v109 row_newbcast:12 row_mask:0xf bank_mask:0xf
  v_dot2c_f32_bf16_dpp v21, v42, v110 row_newbcast:12 row_mask:0xf bank_mask:0xf
  v_dot2c_f32_bf16_dpp v23, v42, v111 row_newbcast:12 row_mask:0xf bank_mask:0xf
  s_branch L_merge
L_merge:
  v_add_f32_dpp v25, v25, v25 row_ror:4 row_mask:0xf bank_mask:0xf
  v_mov_b32 v39, v24
  s_nop 0
  v_add_f32_dpp v25, v25, v25 row_ror:8 row_mask:0xf bank_mask:0xf
  v_mov_b32 v30, v39
  s_nop 1
  v_permlane16_swap_b32 v39, v30
  v_max_f32 v39, v39, v30
  v_mov_b32 v30, v39
  s_nop 1
  v_permlane32_swap_b32 v39, v30
  v_max_f32 v39, v39, v30
  v_sub_f32 v43, v24, v39
  v_exp_f32 v43, v43
  s_nop 0
  v_mul_f32 v25, v25, v43
  v_mul_f32 v16, v16, v43
  v_mul_f32 v17, v17, v43
  v_mul_f32 v18, v18, v43
  v_mul_f32 v19, v19, v43
  v_mul_f32 v20, v20, v43
  v_mul_f32 v21, v21, v43
  v_mul_f32 v22, v22, v43
  v_mul_f32 v23, v23, v43
  v_permlane32_swap_b32 v16, v20
  v_permlane32_swap_b32 v17, v21
  v_permlane32_swap_b32 v18, v22
  v_permlane32_swap_b32 v19, v23
  v_add_f32 v16, v16, v20
  v_add_f32 v17, v17, v21
  v_add_f32 v18, v18, v22
  v_add_f32 v19, v19, v23
  v_mov_b32 v30, v25
  s_nop 1
  v_permlane16_swap_b32 v25, v30
  v_add_f32 v25, v25, v30
  v_mov_b32 v30, v25
  s_nop 1
  v_permlane32_swap_b32 v25, v30
  v_add_f32 v25, v25, v30
  v_permlane16_swap_b32 v16, v18
  v_permlane16_swap_b32 v17, v19
  v_add_f32 v16, v16, v18
  v_add_f32 v17, v17, v19
  v_lshlrev_b32 v30, 3, v3
  v_lshl_add_u32 v30, v4, 5, v30
  s_lshl_b32 s72, s26, 9
  v_add_u32 v30, s72, v30
  ds_write_b64 v30, v[16:17] offset:4352
  v_mov_b32 v36, v39
  v_mov_b32 v37, v25
  s_lshl_b32 s72, s26, 3
  v_mov_b32 v31, s72
  ds_write_b64 v31, v[36:37] offset:6400
  v_and_b32 v30, 127, v0
  v_lshlrev_b32 v31, 2, v30
  s_lshl_b32 s72, s27, 8
  v_lshl_add_u32 v30, v1, 2, s72
  buffer_load_dwordx2 v[160:161], v195, s[40:43], 0 offen sc1
  buffer_load_dwordx2 v[162:163], v187, s[40:43], 0 offen sc1
  s_waitcnt lgkmcnt(0)
  s_barrier
  ds_read_b128 v[112:115], v46 offset:6400
  ds_read_b128 v[116:119], v46 offset:6416
  ds_read_b32 v120, v31 offset:4352
  ds_read_b32 v121, v31 offset:4864
  ds_read_b32 v122, v31 offset:5376
  ds_read_b32 v123, v31 offset:5888
  ds_read_b32 v124, v30 offset:4352
  ds_read_b32 v125, v30 offset:4864
  ds_read_b32 v126, v30 offset:5376
  ds_read_b32 v127, v30 offset:5888
  s_waitcnt lgkmcnt(4)
  v_max3_f32 v128, v112, v114, v116
  v_max_f32 v128, v128, v118
  v_sub_f32 v112, v112, v128
  v_sub_f32 v114, v114, v128
  v_sub_f32 v116, v116, v128
  v_sub_f32 v118, v118, v128
  v_exp_f32 v112, v112
  v_exp_f32 v114, v114
  v_exp_f32 v116, v116
  v_exp_f32 v118, v118
  s_nop 0
  v_mul_f32 v129, v112, v113
  v_mul_f32 v130, v112, v120
  v_fmac_f32 v129, v114, v115
  v_fmac_f32 v130, v114, v121
  v_fmac_f32 v129, v116, v117
  v_fmac_f32 v130, v116, v122
  v_fmac_f32 v129, v118, v119
  v_fmac_f32 v130, v118, v123
  v_rcp_f32 v133, v129
  v_log_f32 v131, v129
  s_waitcnt lgkmcnt(0)
  v_mul_f32 v132, v112, v124
  v_mul_f32 v130, v130, v133
  v_add_f32 v131, v131, v128
  v_min_u32 v130, -2, v130
  v_min_u32 v131, -2, v131
  buffer_store_dwordx2 v[130:131], v194, s[40:43], 0 offen sc1
  v_mov_b32 v170, 1
  buffer_atomic_add v170, v196, s[64:67], 0 offen sc0 sc1
  v_fmac_f32 v132, v114, v125
  v_fmac_f32 v132, v116, v126
  v_fmac_f32 v132, v118, v127
  v_mul_f32 v132, v132, v133
  ds_read_b128 v[48:51], v2 offset:49152
  ds_read_b128 v[52:55], v2 offset:50176
  ds_read_b128 v[56:59], v2 offset:51200
  ds_read_b128 v[60:63], v2 offset:52224
  ds_read_b128 v[64:67], v2 offset:53248
  ds_read_b128 v[68:71], v2 offset:54272
  ds_read_b128 v[72:75], v2 offset:55296
  ds_read_b128 v[76:79], v2 offset:56320
  ds_read_b128 v[80:83], v2 offset:57344
  ds_read_b128 v[84:87], v2 offset:58368
  ds_read_b128 v[88:91], v2 offset:59392
  ds_read_b128 v[92:95], v2 offset:60416
  s_waitcnt lgkmcnt(4)
  ds_read_b128 v[96:99], v2 offset:61440
  ds_read_b128 v[100:103], v2 offset:62464
  ds_read_b128 v[104:107], v2 offset:63488
  ds_read_b128 v[108:111], v2 offset:64512
  s_mov_b32 s82, 2097152
  s_waitcnt vmcnt(2)
  s_branch L_pollO_chk_31
L_pollO_29:
  buffer_load_dwordx2 v[160:161], v195, s[40:43], 0 offen sc1
  buffer_load_dwordx2 v[162:163], v187, s[40:43], 0 offen sc1
  s_waitcnt vmcnt(0)
L_pollO_chk_31:
  v_max3_u32 v45, v160, v161, v162
  v_max_u32 v45, v45, v163
  v_cmp_eq_u32 vcc, -1, v45
  s_sub_u32 s82, s82, 1
  s_cmp_eq_u32 s82, 0
  s_cbranch_scc1 L_pollO_done_30
  s_and_b64 s[84:85], exec, vcc
  s_cbranch_scc0 L_pollO_done_30
  s_mov_b64 exec, s[84:85]
  s_branch L_pollO_29
L_pollO_done_30:
  s_mov_b64 exec, -1
  v_cndmask_b32 v160, v160, v132, s[96:97]
  v_cndmask_b32 v161, v161, v131, s[96:97]
  v_cndmask_b32 v162, v162, v132, s[98:99]
  v_cndmask_b32 v163, v163, v131, s[98:99]
  v_max_f32 v164, v161, v163
  v_sub_f32 v161, v161, v164
  v_sub_f32 v163, v163, v164
  v_exp_f32 v161, v161
  v_exp_f32 v163, v163
  s_nop 0
  v_add_f32 v165, v161, v163
  v_mul_f32 v166, v160, v161
  v_rcp_f32 v164, v165
  v_fmac_f32 v166, v162, v163
  s_waitcnt lgkmcnt(0)
  v_mul_f32 v167, v166, v164
  v_fma_f32 v168, -v167, v165, v166
  v_fma_f32 v166, v168, v164, v167
  v_cvt_pk_bf16_f32 v166, v166, v166
  s_nop 1
  v_and_b32_dpp v144, v166, v8 row_newbcast:0 row_mask:0xf bank_mask:0xf
  v_and_b32_dpp v145, v166, v9 row_newbcast:0 row_mask:0xf bank_mask:0xf
  v_and_b32_dpp v146, v166, v10 row_newbcast:0 row_mask:0xf bank_mask:0xf
  v_and_b32_dpp v147, v166, v11 row_newbcast:0 row_mask:0xf bank_mask:0xf
  v_and_b32_dpp v148, v166, v8 row_newbcast:1 row_mask:0xf bank_mask:0xf
  v_and_b32_dpp v149, v166, v9 row_newbcast:1 row_mask:0xf bank_mask:0xf
  v_and_b32_dpp v150, v166, v10 row_newbcast:1 row_mask:0xf bank_mask:0xf
  v_and_b32_dpp v151, v166, v11 row_newbcast:1 row_mask:0xf bank_mask:0xf
  v_mfma_f32_16x16x32_bf16 v[152:155], v[144:147], v[48:51], 0
  v_and_b32_dpp v144, v166, v8 row_newbcast:2 row_mask:0xf bank_mask:0xf
  v_and_b32_dpp v145, v166, v9 row_newbcast:2 row_mask:0xf bank_mask:0xf
  v_and_b32_dpp v146, v166, v10 row_newbcast:2 row_mask:0xf bank_mask:0xf
  v_and_b32_dpp v147, v166, v11 row_newbcast:2 row_mask:0xf bank_mask:0xf
  v_mfma_f32_16x16x32_bf16 v[152:155], v[148:151], v[52:55], v[152:155]
  v_and_b32_dpp v148, v166, v8 row_newbcast:3 row_mask:0xf bank_mask:0xf
  v_and_b32_dpp v149, v166, v9 row_newbcast:3 row_mask:0xf bank_mask:0xf
  v_and_b32_dpp v150, v166, v10 row_newbcast:3 row_mask:0xf bank_mask:0xf
  v_and_b32_dpp v151, v166, v11 row_newbcast:3 row_mask:0xf bank_mask:0xf
  v_mfma_f32_16x16x32_bf16 v[152:155], v[144:147], v[56:59], v[152:155]
  v_and_b32_dpp v144, v166, v8 row_newbcast:4 row_mask:0xf bank_mask:0xf
  v_and_b32_dpp v145, v166, v9 row_newbcast:4 row_mask:0xf bank_mask:0xf
  v_and_b32_dpp v146, v166, v10 row_newbcast:4 row_mask:0xf bank_mask:0xf
  v_and_b32_dpp v147, v166, v11 row_newbcast:4 row_mask:0xf bank_mask:0xf
  v_mfma_f32_16x16x32_bf16 v[152:155], v[148:151], v[60:63], v[152:155]
  v_and_b32_dpp v148, v166, v8 row_newbcast:5 row_mask:0xf bank_mask:0xf
  v_and_b32_dpp v149, v166, v9 row_newbcast:5 row_mask:0xf bank_mask:0xf
  v_and_b32_dpp v150, v166, v10 row_newbcast:5 row_mask:0xf bank_mask:0xf
  v_and_b32_dpp v151, v166, v11 row_newbcast:5 row_mask:0xf bank_mask:0xf
  v_mfma_f32_16x16x32_bf16 v[152:155], v[144:147], v[64:67], v[152:155]
  v_and_b32_dpp v144, v166, v8 row_newbcast:6 row_mask:0xf bank_mask:0xf
  v_and_b32_dpp v145, v166, v9 row_newbcast:6 row_mask:0xf bank_mask:0xf
  v_and_b32_dpp v146, v166, v10 row_newbcast:6 row_mask:0xf bank_mask:0xf
  v_and_b32_dpp v147, v166, v11 row_newbcast:6 row_mask:0xf bank_mask:0xf
  v_mfma_f32_16x16x32_bf16 v[152:155], v[148:151], v[68:71], v[152:155]
  v_and_b32_dpp v148, v166, v8 row_newbcast:7 row_mask:0xf bank_mask:0xf
  v_and_b32_dpp v149, v166, v9 row_newbcast:7 row_mask:0xf bank_mask:0xf
  v_and_b32_dpp v150, v166, v10 row_newbcast:7 row_mask:0xf bank_mask:0xf
  v_and_b32_dpp v151, v166, v11 row_newbcast:7 row_mask:0xf bank_mask:0xf
  v_mfma_f32_16x16x32_bf16 v[152:155], v[144:147], v[72:75], v[152:155]
  v_and_b32_dpp v144, v166, v8 row_newbcast:8 row_mask:0xf bank_mask:0xf
  v_and_b32_dpp v145, v166, v9 row_newbcast:8 row_mask:0xf bank_mask:0xf
  v_and_b32_dpp v146, v166, v10 row_newbcast:8 row_mask:0xf bank_mask:0xf
  v_and_b32_dpp v147, v166, v11 row_newbcast:8 row_mask:0xf bank_mask:0xf
  v_mfma_f32_16x16x32_bf16 v[152:155], v[148:151], v[76:79], v[152:155]
  v_and_b32_dpp v148, v166, v8 row_newbcast:9 row_mask:0xf bank_mask:0xf
  v_and_b32_dpp v149, v166, v9 row_newbcast:9 row_mask:0xf bank_mask:0xf
  v_and_b32_dpp v150, v166, v10 row_newbcast:9 row_mask:0xf bank_mask:0xf
  v_and_b32_dpp v151, v166, v11 row_newbcast:9 row_mask:0xf bank_mask:0xf
  v_mfma_f32_16x16x32_bf16 v[152:155], v[144:147], v[80:83], v[152:155]
  v_and_b32_dpp v144, v166, v8 row_newbcast:10 row_mask:0xf bank_mask:0xf
  v_and_b32_dpp v145, v166, v9 row_newbcast:10 row_mask:0xf bank_mask:0xf
  v_and_b32_dpp v146, v166, v10 row_newbcast:10 row_mask:0xf bank_mask:0xf
  v_and_b32_dpp v147, v166, v11 row_newbcast:10 row_mask:0xf bank_mask:0xf
  v_mfma_f32_16x16x32_bf16 v[152:155], v[148:151], v[84:87], v[152:155]
  v_and_b32_dpp v148, v166, v8 row_newbcast:11 row_mask:0xf bank_mask:0xf
  v_and_b32_dpp v149, v166, v9 row_newbcast:11 row_mask:0xf bank_mask:0xf
  v_and_b32_dpp v150, v166, v10 row_newbcast:11 row_mask:0xf bank_mask:0xf
  v_and_b32_dpp v151, v166, v11 row_newbcast:11 row_mask:0xf bank_mask:0xf
  v_mfma_f32_16x16x32_bf16 v[152:155], v[144:147], v[88:91], v[152:155]
  v_and_b32_dpp v144, v166, v8 row_newbcast:12 row_mask:0xf bank_mask:0xf
  v_and_b32_dpp v145, v166, v9 row_newbcast:12 row_mask:0xf bank_mask:0xf
  v_and_b32_dpp v146, v166, v10 row_newbcast:12 row_mask:0xf bank_mask:0xf
  v_and_b32_dpp v147, v166, v11 row_newbcast:12 row_mask:0xf bank_mask:0xf
  v_mfma_f32_16x16x32_bf16 v[152:155], v[148:151], v[92:95], v[152:155]
  v_and_b32_dpp v148, v166, v8 row_newbcast:13 row_mask:0xf bank_mask:0xf
  v_and_b32_dpp v149, v166, v9 row_newbcast:13 row_mask:0xf bank_mask:0xf
  v_and_b32_dpp v150, v166, v10 row_newbcast:13 row_mask:0xf bank_mask:0xf
  v_and_b32_dpp v151, v166, v11 row_newbcast:13 row_mask:0xf bank_mask:0xf
  v_mfma_f32_16x16x32_bf16 v[152:155], v[144:147], v[96:99], v[152:155]
  v_and_b32_dpp v144, v166, v8 row_newbcast:14 row_mask:0xf bank_mask:0xf
  v_and_b32_dpp v145, v166, v9 row_newbcast:14 row_mask:0xf bank_mask:0xf
  v_and_b32_dpp v146, v166, v10 row_newbcast:14 row_mask:0xf bank_mask:0xf
  v_and_b32_dpp v147, v166, v11 row_newbcast:14 row_mask:0xf bank_mask:0xf
  v_mfma_f32_16x16x32_bf16 v[152:155], v[148:151], v[100:103], v[152:155]
  v_and_b32_dpp v148, v166, v8 row_newbcast:15 row_mask:0xf bank_mask:0xf
  v_and_b32_dpp v149, v166, v9 row_newbcast:15 row_mask:0xf bank_mask:0xf
  v_and_b32_dpp v150, v166, v10 row_newbcast:15 row_mask:0xf bank_mask:0xf
  v_and_b32_dpp v151, v166, v11 row_newbcast:15 row_mask:0xf bank_mask:0xf
  v_mfma_f32_16x16x32_bf16 v[152:155], v[144:147], v[104:107], v[152:155]
  s_nop 0
  v_mfma_f32_16x16x32_bf16 v[152:155], v[148:151], v[108:111], v[152:155]
  s_nop 7
  v_min_u32 v152, -2, v152
  v_min_u32 v153, -2, v153
  v_min_u32 v154, -2, v154
  v_min_u32 v155, -2, v155
  buffer_store_dwordx4 v[152:155], v186, s[40:43], 0 offen sc1
  s_waitcnt vmcnt(1)
  s_cmp_eq_u32 s26, 0
  s_cbranch_scc0 L_rkw_32
  s_mov_b64 exec, 1
  ds_write_b32 v46, v170 offset:6448
  s_mov_b64 exec, -1
  s_waitcnt lgkmcnt(0)
L_rkw_32:
  s_barrier
  ds_read_b32 v170, v46 offset:6448
  s_waitcnt lgkmcnt(0)
  v_readfirstlane_b32 s81, v170
  s_cmp_lt_u32 s81, 43
  s_cbranch_scc1 L_ffn
  s_cmp_ge_u32 s26, 2
  s_cbranch_scc1 L_exit
  s_cmp_ge_u32 s81, 171
  s_cbranch_scc1 L_exit
  s_sub_u32 s72, s81, 43
  s_lshl_b32 s72, s72, 1
  s_add_u32 s72, s72, s26
  s_mov_b32 s83, 1
  v_mov_b32 v160, 0x7ff00000
  s_and_b32 s73, s72, 63
  s_lshr_b32 s76, s72, 6
  v_lshrrev_b32 v161, 3, v1
  s_lshl_b32 s74, s72, 5
  s_add_u32 s74, s74, 851968
  v_lshl_add_u32 v188, v161, 2, s74
  s_lshl_b32 s74, s72, 4
  v_lshl_add_u32 v192, v161, 1, s74
  buffer_load_ushort v184, v192, s[52:55], 0 offen
  s_cmp_eq_u32 s83, 1
  s_cselect_b32 s74, 0, 8
  v_and_b32 v161, 7, v1
  v_or_b32 v161, s74, v161
  v_cmp_eq_u32 vcc, 0, v161
  s_nop 1
  v_cndmask_b32 v188, v160, v188, vcc
  v_mov_b32 v162, v192
  v_cndmask_b32 v192, v160, v162, vcc
  s_lshl_b32 s74, s76, 17
  s_lshl_b32 s75, s73, 5
  s_add_u32 s74, s74, s75
  s_add_u32 s74, s74, 65536
  v_lshl_add_u32 v190, v1, 11, s74
  s_lshl_b32 s74, s76, 11
  s_add_u32 s74, s74, s75
  s_add_u32 s74, s74, 868352
  v_lshl_add_u32 v191, v1, 13, s74
  v_cmp_gt_u32 vcc, 43, v1
  s_nop 1
  v_cndmask_b32 v191, v160, v191, vcc
  s_waitcnt vmcnt(0)
  v_lshlrev_b32 v184, 16, v184
L_red:
  s_mov_b32 s82, 2097152
L_pollY_33:
  buffer_load_dwordx4 v[48:51], v190, s[40:43], 0 offen sc1
  buffer_load_dwordx4 v[52:55], v190, s[40:43], 0 offen offset:16 sc1
  s_waitcnt vmcnt(0)
L_pollY_chk_35:
  v_max3_u32 v45, v48, v49, v50
  v_max3_u32 v45, v45, v51, v52
  v_max3_u32 v45, v45, v53, v54
  v_max_u32 v45, v45, v55
  v_cmp_eq_u32 vcc, -1, v45
  s_sub_u32 s82, s82, 1
  s_cmp_eq_u32 s82, 0
  s_cbranch_scc1 L_pollY_done_34
  s_and_b64 s[84:85], exec, vcc
  s_cbranch_scc0 L_pollY_done_34
  s_mov_b64 exec, s[84:85]
  s_branch L_pollY_33
L_pollY_done_34:
  s_mov_b64 exec, -1
  v_permlane32_swap_b32 v48, v52
  v_permlane32_swap_b32 v49, v53
  v_permlane32_swap_b32 v50, v54
  v_permlane32_swap_b32 v51, v55
  v_add_f32 v48, v48, v52
  v_add_f32 v49, v49, v53
  v_add_f32 v50, v50, v54
  v_add_f32 v51, v51, v55
  s_nop 0
  v_permlane16_swap_b32 v48, v50
  v_permlane16_swap_b32 v49, v51
  v_add_f32 v48, v48, v50
  v_add_f32 v49, v49, v51
  s_nop 0
  v_add_f32_dpp v50, v48, v48 row_ror:8 row_mask:0xf bank_mask:0x3
  s_nop 1
  v_add_f32_dpp v50, v49, v49 row_ror:8 row_mask:0xf bank_mask:0xc
  s_nop 1
  v_add_f32_dpp v48, v50, v50 row_half_mirror row_mask:0xf bank_mask:0xf
  s_nop 1
  v_add_f32_dpp v48, v48, v48 quad_perm:[1,0,3,2] row_mask:0xf bank_mask:0xf
  s_nop 1
  v_add_f32_dpp v48, v48, v48 quad_perm:[2,3,0,1] row_mask:0xf bank_mask:0xf
  v_cvt_pk_bf16_f32 v48, v48, v48
  v_and_b32 v48, 0xffff0000, v48
  v_add_f32 v185, v184, v48
  v_cvt_pk_bf16_f32 v185, v185, v185
  v_and_b32 v185, 0xffff0000, v185
  v_min_u32 v49, -2, v185
  buffer_store_dword v49, v188, s[40:43], 0 offen sc1
  s_branch L_final
L_ffn:
  s_mul_i32 s78, s26, 352256
  s_lshl_b32 s79, s81, 6
  s_add_u32 s78, s78, s79
  s_lshl_b32 s79, s26, 13
  s_add_u32 s79, s79, 16384
  s_mov_b32 m0, s79
  s_add_u32 s79, s79, 1024
  buffer_load_dwordx4 v7, s[44:47], s78 offen lds
  s_add_u32 s78, s78, 44032
  s_mov_b32 m0, s79
  s_add_u32 s79, s79, 1024
  buffer_load_dwordx4 v7, s[44:47], s78 offen lds
  s_add_u32 s78, s78, 44032
  s_mov_b32 m0, s79
  s_add_u32 s79, s79, 1024
  buffer_load_dwordx4 v7, s[44:47], s78 offen lds
  s_add_u32 s78, s78, 44032
  s_mov_b32 m0, s79
  s_add_u32 s79, s79, 1024
  buffer_load_dwordx4 v7, s[44:47], s78 offen lds
  s_add_u32 s78, s78, 44032
  s_mov_b32 m0, s79
  s_add_u32 s79, s79, 1024
  buffer_load_dwordx4 v7, s[44:47], s78 offen lds
  s_add_u32 s78, s78, 44032
  s_mov_b32 m0, s79
  s_add_u32 s79, s79, 1024
  buffer_load_dwordx4 v7, s[44:47], s78 offen lds
  s_add_u32 s78, s78, 44032
  s_mov_b32 m0, s79
  s_add_u32 s79, s79, 1024
  buffer_load_dwordx4 v7, s[44:47], s78 offen lds
  s_add_u32 s78, s78, 44032
  s_mov_b32 m0, s79
  s_add_u32 s79, s79, 1024
  buffer_load_dwordx4 v7, s[44:47], s78 offen lds
  s_add_u32 s78, s78, 44032
  s_lshl_b32 s78, s81, 15
  s_lshl_b32 s79, s26, 8
  s_add_u32 s78, s78, s79
  buffer_load_dwordx4 a[128:131], v5, s[48:51], s78 offen
  s_add_u32 s78, s78, 4096
  buffer_load_dwordx4 a[132:135], v5, s[48:51], s78 offen
  s_add_u32 s78, s78, 4096
  buffer_load_dwordx4 a[136:139], v5, s[48:51], s78 offen
  s_add_u32 s78, s78, 4096
  buffer_load_dwordx4 a[140:143], v5, s[48:51], s78 offen
  s_add_u32 s78, s78, 4096
  buffer_load_dwordx4 a[144:147], v5, s[48:51], s78 offen
  s_add_u32 s78, s78, 4096
  buffer_load_dwordx4 a[148:151], v5, s[48:51], s78 offen
  s_add_u32 s78, s78, 4096
  buffer_load_dwordx4 a[152:155], v5, s[48:51], s78 offen
  s_add_u32 s78, s78, 4096
  buffer_load_dwordx4 a[156:159], v5, s[48:51], s78 offen
  s_add_u32 s78, s78, 4096
  v_and_b32 v161, 1, v3
  v_lshlrev_b32 v161, 4, v161
  v_lshl_add_u32 v161, v4, 5, v161
  s_lshl_b32 s72, s81, 13
  s_lshl_b32 s73, s26, 9
  s_add_u32 s72, s72, s73
  s_add_u32 s72, s72, 868352
  v_lshrrev_b32 v162, 1, v3
  v_lshl_add_u32 v162, v162, 11, v161
  v_add_u32 v189, s72, v162
  s_waitcnt vmcnt(8)
  s_barrier
  s_cmp_lt_u32 s26, 2
  s_cbranch_scc1 L_nob1_36
  v_lshrrev_b32 v30, 2, v4
  v_lshl_add_u32 v30, v3, 3, v30
  v_lshlrev_b32 v30, 6, v30
  v_and_b32 v31, 3, v4
  v_lshl_add_u32 v30, v31, 3, v30
  s_sub_u32 s72, s26, 2
  s_lshl_b32 s72, s72, 5
  v_add_u32 v30, s72, v30
  ds_read_b64_tr_b16 a[160:161], v30 offset:16384
  ds_read_b64_tr_b16 a[162:163], v30 offset:16640
  ds_read_b64_tr_b16 a[164:165], v30 offset:18432
  ds_read_b64_tr_b16 a[166:167], v30 offset:18688
  ds_read_b64_tr_b16 a[168:169], v30 offset:20480
  ds_read_b64_tr_b16 a[170:171], v30 offset:20736
  ds_read_b64_tr_b16 a[172:173], v30 offset:22528
  ds_read_b64_tr_b16 a[174:175], v30 offset:22784
  s_waitcnt lgkmcnt(0)
  ds_read_b64_tr_b16 a[176:177], v30 offset:24576
  ds_read_b64_tr_b16 a[178:179], v30 offset:24832
  ds_read_b64_tr_b16 a[180:181], v30 offset:26624
  ds_read_b64_tr_b16 a[182:183], v30 offset:26880
  ds_read_b64_tr_b16 a[184:185], v30 offset:28672
  ds_read_b64_tr_b16 a[186:187], v30 offset:28928
  ds_read_b64_tr_b16 a[188:189], v30 offset:30720
  ds_read_b64_tr_b16 a[190:191], v30 offset:30976
  s_waitcnt lgkmcnt(0)
  ds_read_b64_tr_b16 a[192:193], v30 offset:32768
  ds_read_b64_tr_b16 a[194:195], v30 offset:33024
  ds_read_b64_tr_b16 a[196:197], v30 offset:34816
  ds_read_b64_tr_b16 a[198:199], v30 offset:35072
  ds_read_b64_tr_b16 a[200:201], v30 offset:36864
  ds_read_b64_tr_b16 a[202:203], v30 offset:37120
  ds_read_b64_tr_b16 a[204:205], v30 offset:38912
  ds_read_b64_tr_b16 a[206:207], v30 offset:39168
  s_waitcnt lgkmcnt(0)
  ds_read_b64_tr_b16 a[208:209], v30 offset:40960
  ds_read_b64_tr_b16 a[210:211], v30 offset:41216
  ds_read_b64_tr_b16 a[212:213], v30 offset:43008
  ds_read_b64_tr_b16 a[214:215], v30 offset:43264
  ds_read_b64_tr_b16 a[216:217], v30 offset:45056
  ds_read_b64_tr_b16 a[218:219], v30 offset:45312
  ds_read_b64_tr_b16 a[220:221], v30 offset:47104
  ds_read_b64_tr_b16 a[222:223], v30 offset:47360
  s_waitcnt lgkmcnt(0)
L_nob1_36:
  s_mul_i32 s72, s26, 1088
  v_add_u32 v204, s72, v2
  v_and_b32 v30, 3, v4
  v_mul_u32_u24 v205, 1088, v30
  v_lshl_add_u32 v205, v3, 4, v205
  v_mul_u32_u24 v206, 48, v30
  v_lshrrev_b32 v31, 2, v4
  v_lshl_add_u32 v206, v31, 2, v206
  s_and_b32 s72, s26, 1
  s_lshl_b32 s72, s72, 4
  v_add_u32 v206, s72, v206
  v_lshrrev_b32 v30, 3, v4
  v_lshl_add_u32 v30, v30, 2, v3
  v_mul_u32_u24 v207, 48, v30
  s_lshl_b32 s72, s26, 11
  s_add_u32 s72, s72, 851968
  v_lshlrev_b32 v208, 5, v1
  v_add_u32 v208, s72, v208
  s_mov_b32 s82, 2097152
  s_mov_b64 exec, 1
L_pollH_can_40:
  buffer_load_dword v45, v208, s[40:43], 0 offen sc1
  s_waitcnt vmcnt(0)
  v_cmp_eq_u32 vcc, -1, v45
  s_sub_u32 s82, s82, 1
  s_cmp_eq_u32 s82, 0
  s_cbranch_scc1 L_pollH_cand_41
  s_cbranch_vccz L_pollH_cand_41
  s_branch L_pollH_can_40
L_pollH_cand_41:
  s_mov_b64 exec, -1
  s_mov_b32 s82, 2097152
L_pollH_37:
  buffer_load_dwordx4 v[48:51], v208, s[40:43], 0 offen sc1
  buffer_load_dwordx4 v[52:55], v208, s[40:43], 0 offen offset:16 sc1
  s_waitcnt vmcnt(0)
L_pollH_chk_39:
  v_max3_u32 v45, v48, v49, v50
  v_max3_u32 v45, v45, v51, v52
  v_max3_u32 v45, v45, v53, v54
  v_max_u32 v45, v45, v55
  v_cmp_eq_u32 vcc, -1, v45
  s_sub_u32 s82, s82, 1
  s_cmp_eq_u32 s82, 0
  s_cbranch_scc1 L_pollH_done_38
  s_and_b64 s[84:85], exec, vcc
  s_cbranch_scc0 L_pollH_done_38
  s_mov_b64 exec, s[84:85]
  s_branch L_pollH_37
L_pollH_done_38:
  s_mov_b64 exec, -1
  v_readfirstlane_b32 s73, v48
  s_nop 1
  v_subrev_f32 v72, s73, v48
  v_subrev_f32 v73, s73, v49
  v_subrev_f32 v74, s73, v50
  v_subrev_f32 v75, s73, v51
  v_subrev_f32 v76, s73, v52
  v_subrev_f32 v77, s73, v53
  v_subrev_f32 v78, s73, v54
  v_subrev_f32 v79, s73, v55
  v_add_f32 v56, v72, v73
  v_mul_f32 v57, v72, v72
  v_add_f32 v58, v74, v75
  v_mul_f32 v60, v73, v73
  v_add_f32 v59, v76, v77
  v_fmac_f32 v57, v74, v74
  v_add_f32 v56, v56, v58
  v_fmac_f32 v60, v75, v75
  v_add_f32 v58, v78, v79
  v_fmac_f32 v57, v76, v76
  v_add_f32 v59, v59, v58
  v_fmac_f32 v60, v77, v77
  v_add_f32 v56, v56, v59
  v_fmac_f32 v57, v78, v78
  v_fmac_f32 v60, v79, v79
  v_add_f32 v57, v57, v60
  v_add_f32_dpp v56, v56, v56 row_ror:8 row_mask:0xf bank_mask:0xf
  s_nop 0
  v_add_f32_dpp v57, v57, v57 row_ror:8 row_mask:0xf bank_mask:0xf
  v_add_f32_dpp v56, v56, v56 row_ror:4 row_mask:0xf bank_mask:0xf
  s_nop 0
  v_add_f32_dpp v57, v57, v57 row_ror:4 row_mask:0xf bank_mask:0xf
  v_add_f32_dpp v56, v56, v56 row_ror:2 row_mask:0xf bank_mask:0xf
  s_nop 0
  v_add_f32_dpp v57, v57, v57 row_ror:2 row_mask:0xf bank_mask:0xf
  v_add_f32_dpp v56, v56, v56 row_ror:1 row_mask:0xf bank_mask:0xf
  s_nop 0
  v_add_f32_dpp v57, v57, v57 row_ror:1 row_mask:0xf bank_mask:0xf
  v_mov_b32 v58, v56
  v_mov_b32 v59, v57
  s_nop 0
  v_permlane16_swap_b32 v56, v58
  v_permlane16_swap_b32 v57, v59
  v_add_f32 v56, v56, v58
  v_add_f32 v57, v57, v59
  v_mov_b32 v58, v56
  v_mov_b32 v59, v57
  s_nop 0
  v_permlane32_swap_b32 v56, v58
  v_permlane32_swap_b32 v57, v59
  v_add_f32 v56, v56, v58
  v_add_f32 v57, v57, v59
  v_mul_f32 v56, 0x3b000000, v56
  v_mul_f32 v57, 0x3b000000, v57
  v_add_f32 v58, s73, v56
  v_fma_f32 v57, -v56, v56, v57
  v_cvt_pk_bf16_f32 v58, v58, v58
  v_and_b32 v58, 0xffff0000, v58
  v_max_f32 v57, 0, v57
  v_cvt_pk_bf16_f32 v57, v57, v57
  v_and_b32 v57, 0xffff0000, v57
  v_add_f32 v57, 0x3727c5ac, v57
  v_cvt_pk_bf16_f32 v57, v57, v57
  v_and_b32 v57, 0xffff0000, v57
  v_sqrt_f32 v57, v57
  v_sub_f32 v48, v48, v58
  v_sub_f32 v49, v49, v58
  v_sub_f32 v50, v50, v58
  v_sub_f32 v51, v51, v58
  v_sub_f32 v52, v52, v58
  v_sub_f32 v53, v53, v58
  v_sub_f32 v54, v54, v58
  v_sub_f32 v55, v55, v58
  v_cvt_pk_bf16_f32 v57, v57, v57
  v_and_b32 v57, 0xffff0000, v57
  v_rcp_f32 v60, v57
  v_cvt_pk_bf16_f32 v48, v48, v48
  v_and_b32 v48, 0xffff0000, v48
  v_cvt_pk_bf16_f32 v49, v49, v49
  v_and_b32 v49, 0xffff0000, v49
  v_cvt_pk_bf16_f32 v50, v50, v50
  v_and_b32 v50, 0xffff0000, v50
  v_cvt_pk_bf16_f32 v51, v51, v51
  v_and_b32 v51, 0xffff0000, v51
  v_cvt_pk_bf16_f32 v52, v52, v52
  v_and_b32 v52, 0xffff0000, v52
  v_cvt_pk_bf16_f32 v53, v53, v53
  v_and_b32 v53, 0xffff0000, v53
  v_cvt_pk_bf16_f32 v54, v54, v54
  v_and_b32 v54, 0xffff0000, v54
  v_cvt_pk_bf16_f32 v55, v55, v55
  v_and_b32 v55, 0xffff0000, v55
  v_mul_f32 v48, v48, v60
  v_mul_f32 v49, v49, v60
  v_mul_f32 v50, v50, v60
  v_mul_f32 v51, v51, v60
  v_mul_f32 v52, v52, v60
  v_mul_f32 v53, v53, v60
  v_mul_f32 v54, v54, v60
  v_mul_f32 v55, v55, v60
  v_cvt_pk_bf16_f32 v64, v48, v49
  v_cvt_pk_bf16_f32 v65, v50, v51
  v_cvt_pk_bf16_f32 v66, v52, v53
  v_cvt_pk_bf16_f32 v67, v54, v55
  ds_write_b128 v204, v[64:67] offset:7808
  s_waitcnt lgkmcnt(0)
  s_barrier
  s_cmp_lt_u32 s26, 2
  s_cbranch_scc1 L_ffn2
  ds_read_b128 v[48:51], v205 offset:7808
  ds_read_b128 v[52:55], v205 offset:7872
  ds_read_b128 v[56:59], v205 offset:7936
  ds_read_b128 v[60:63], v205 offset:8000
  ds_read_b128 v[64:67], v205 offset:8064
  ds_read_b128 v[68:71], v205 offset:8128
  ds_read_b128 v[72:75], v205 offset:8192
  ds_read_b128 v[76:79], v205 offset:8256
  ds_read_b128 v[80:83], v205 offset:8320
  ds_read_b128 v[84:87], v205 offset:8384
  ds_read_b128 v[88:91], v205 offset:8448
  ds_read_b128 v[92:95], v205 offset:8512
  s_waitcnt lgkmcnt(8)
  v_mfma_f32_16x16x32_bf16 v[152:155], v[48:51], a[160:163], 0
  v_mfma_f32_16x16x32_bf16 v[152:155], v[52:55], a[164:167], v[152:155]
  v_mfma_f32_16x16x32_bf16 v[152:155], v[56:59], a[168:171], v[152:155]
  v_mfma_f32_16x16x32_bf16 v[152:155], v[60:63], a[172:175], v[152:155]
  ds_read_b128 v[96:99], v205 offset:8576
  ds_read_b128 v[100:103], v205 offset:8640
  ds_read_b128 v[104:107], v205 offset:8704
  ds_read_b128 v[108:111], v205 offset:8768
  s_waitcnt lgkmcnt(8)
  v_mfma_f32_16x16x32_bf16 v[152:155], v[64:67], a[176:179], v[152:155]
  v_mfma_f32_16x16x32_bf16 v[152:155], v[68:71], a[180:183], v[152:155]
  v_mfma_f32_16x16x32_bf16 v[152:155], v[72:75], a[184:187], v[152:155]
  v_mfma_f32_16x16x32_bf16 v[152:155], v[76:79], a[188:191], v[152:155]
  s_waitcnt lgkmcnt(4)
  v_mfma_f32_16x16x32_bf16 v[152:155], v[80:83], a[192:195], v[152:155]
  v_mfma_f32_16x16x32_bf16 v[152:155], v[84:87], a[196:199], v[152:155]
  v_mfma_f32_16x16x32_bf16 v[152:155], v[88:91], a[200:203], v[152:155]
  v_mfma_f32_16x16x32_bf16 v[152:155], v[92:95], a[204:207], v[152:155]
  s_waitcnt lgkmcnt(0)
  v_mfma_f32_16x16x32_bf16 v[152:155], v[96:99], a[208:211], v[152:155]
  v_mfma_f32_16x16x32_bf16 v[152:155], v[100:103], a[212:215], v[152:155]
  v_mfma_f32_16x16x32_bf16 v[152:155], v[104:107], a[216:219], v[152:155]
  v_mfma_f32_16x16x32_bf16 v[152:155], v[108:111], a[220:223], v[152:155]
  s_nop 7
  v_max_f32 v152, 0, v152
  v_max_f32 v153, 0, v153
  v_max_f32 v154, 0, v154
  v_max_f32 v155, 0, v155
  v_cvt_pk_bf16_f32 v152, v152, v152
  v_cvt_pk_bf16_f32 v153, v153, v153
  v_cvt_pk_bf16_f32 v154, v154, v154
  v_cvt_pk_bf16_f32 v155, v155, v155
  ds_write_b32 v206, v152 offset:12160
  ds_write_b32 v206, v153 offset:12352
  ds_write_b32 v206, v154 offset:12544
  ds_write_b32 v206, v155 offset:12736
  s_waitcnt lgkmcnt(0)
L_ffn2:
  s_barrier
  ds_read_b128 v[112:115], v207 offset:12160
  ds_read_b128 v[116:119], v207 offset:12176
  ds_read_b128 v[120:123], v207 offset:12544
  ds_read_b128 v[124:127], v207 offset:12560
  s_waitcnt lgkmcnt(0)
  v_and_b32 v144, v112, v8
  v_and_b32 v145, v112, v9
  v_and_b32 v146, v112, v10
  v_and_b32 v147, v112, v11
  v_and_b32 v148, v113, v8
  v_and_b32 v149, v113, v9
  v_and_b32 v150, v113, v10
  v_and_b32 v151, v113, v11
  v_mfma_f32_16x16x32_bf16 v[152:155], v[144:147], a[128:131], 0
  v_and_b32 v144, v114, v8
  v_and_b32 v145, v114, v9
  v_and_b32 v146, v114, v10
  v_and_b32 v147, v114, v11
  v_mfma_f32_16x16x32_bf16 v[152:155], v[148:151], a[132:135], v[152:155]
  v_and_b32 v148, v115, v8
  v_and_b32 v149, v115, v9
  v_and_b32 v150, v115, v10
  v_and_b32 v151, v115, v11
  v_mfma_f32_16x16x32_bf16 v[152:155], v[144:147], a[136:139], v[152:155]
  v_and_b32 v144, v116, v8
  v_and_b32 v145, v116, v9
  v_and_b32 v146, v116, v10
  v_and_b32 v147, v116, v11
  v_mfma_f32_16x16x32_bf16 v[152:155], v[148:151], a[140:143], v[152:155]
  v_and_b32 v148, v117, v8
  v_and_b32 v149, v117, v9
  v_and_b32 v150, v117, v10
  v_and_b32 v151, v117, v11
  v_mfma_f32_16x16x32_bf16 v[152:155], v[144:147], a[144:147], v[152:155]
  v_and_b32 v144, v118, v8
  v_and_b32 v145, v118, v9
  v_and_b32 v146, v118, v10
  v_and_b32 v147, v118, v11
  v_mfma_f32_16x16x32_bf16 v[152:155], v[148:151], a[148:151], v[152:155]
  v_and_b32 v148, v119, v8
  v_and_b32 v149, v119, v9
  v_and_b32 v150, v119, v10
  v_and_b32 v151, v119, v11
  v_mfma_f32_16x16x32_bf16 v[152:155], v[144:147], a[152:155], v[152:155]
  s_nop 0
  v_mfma_f32_16x16x32_bf16 v[152:155], v[148:151], a[156:159], v[152:155]
  v_and_b32 v144, v120, v8
  v_and_b32 v145, v120, v9
  v_and_b32 v146, v120, v10
  v_and_b32 v147, v120, v11
  v_and_b32 v148, v121, v8
  v_and_b32 v149, v121, v9
  v_and_b32 v150, v121, v10
  v_and_b32 v151, v121, v11
  v_mfma_f32_16x16x32_bf16 v[156:159], v[144:147], a[128:131], 0
  v_and_b32 v144, v122, v8
  v_and_b32 v145, v122, v9
  v_and_b32 v146, v122, v10
  v_and_b32 v147, v122, v11
  v_mfma_f32_16x16x32_bf16 v[156:159], v[148:151], a[132:135], v[156:159]
  v_and_b32 v148, v123, v8
  v_and_b32 v149, v123, v9
  v_and_b32 v150, v123, v10
  v_and_b32 v151, v123, v11
  v_mfma_f32_16x16x32_bf16 v[156:159], v[144:147], a[136:139], v[156:159]
  v_and_b32 v144, v124, v8
  v_and_b32 v145, v124, v9
  v_and_b32 v146, v124, v10
  v_and_b32 v147, v124, v11
  v_mfma_f32_16x16x32_bf16 v[156:159], v[148:151], a[140:143], v[156:159]
  v_and_b32 v148, v125, v8
  v_and_b32 v149, v125, v9
  v_and_b32 v150, v125, v10
  v_and_b32 v151, v125, v11
  v_mfma_f32_16x16x32_bf16 v[156:159], v[144:147], a[144:147], v[156:159]
  v_and_b32 v144, v126, v8
  v_and_b32 v145, v126, v9
  v_and_b32 v146, v126, v10
  v_and_b32 v147, v126, v11
  v_mfma_f32_16x16x32_bf16 v[156:159], v[148:151], a[148:151], v[156:159]
  v_and_b32 v148, v127, v8
  v_and_b32 v149, v127, v9
  v_and_b32 v150, v127, v10
  v_and_b32 v151, v127, v11
  v_mfma_f32_16x16x32_bf16 v[156:159], v[144:147], a[152:155], v[156:159]
  s_nop 0
  v_mfma_f32_16x16x32_bf16 v[156:159], v[148:151], a[156:159], v[156:159]
  v_min_u32 v152, -2, v152
  v_min_u32 v153, -2, v153
  v_min_u32 v154, -2, v154
  v_min_u32 v155, -2, v155
  s_nop 3
  v_min_u32 v156, -2, v156
  v_min_u32 v157, -2, v157
  v_min_u32 v158, -2, v158
  v_min_u32 v159, -2, v159
  buffer_store_dwordx4 v[152:155], v189, s[40:43], 0 offen sc1
  buffer_store_dwordx4 v[156:159], v189, s[40:43], s91 offen sc1
  s_branch L_exit
L_final:
  s_mov_b32 s82, 2097152
  s_mov_b64 exec, 1
L_pollP_can_45:
  buffer_load_dword v45, v191, s[40:43], 0 offen sc1
  s_waitcnt vmcnt(0)
  v_cmp_eq_u32 vcc, -1, v45
  s_sub_u32 s82, s82, 1
  s_cmp_eq_u32 s82, 0
  s_cbranch_scc1 L_pollP_cand_46
  s_cbranch_vccz L_pollP_cand_46
  s_branch L_pollP_can_45
L_pollP_cand_46:
  s_mov_b64 exec, -1
  s_mov_b32 s82, 2097152
L_pollP_42:
  buffer_load_dwordx4 v[48:51], v191, s[40:43], 0 offen sc1
  buffer_load_dwordx4 v[52:55], v191, s[40:43], 0 offen offset:16 sc1
  s_waitcnt vmcnt(0)
L_pollP_chk_44:
  v_max3_u32 v45, v48, v49, v50
  v_max3_u32 v45, v45, v51, v52
  v_max3_u32 v45, v45, v53, v54
  v_max_u32 v45, v45, v55
  v_cmp_eq_u32 vcc, -1, v45
  s_sub_u32 s82, s82, 1
  s_cmp_eq_u32 s82, 0
  s_cbranch_scc1 L_pollP_done_43
  s_and_b64 s[84:85], exec, vcc
  s_cbranch_scc0 L_pollP_done_43
  s_mov_b64 exec, s[84:85]
  s_branch L_pollP_42
L_pollP_done_43:
  s_mov_b64 exec, -1
  v_permlane32_swap_b32 v48, v52
  v_permlane32_swap_b32 v49, v53
  v_permlane32_swap_b32 v50, v54
  v_permlane32_swap_b32 v51, v55
  v_add_f32 v48, v48, v52
  v_add_f32 v49, v49, v53
  v_add_f32 v50, v50, v54
  v_add_f32 v51, v51, v55
  s_nop 0
  v_permlane16_swap_b32 v48, v50
  v_permlane16_swap_b32 v49, v51
  v_add_f32 v48, v48, v50
  v_add_f32 v49, v49, v51
  s_nop 0
  v_add_f32_dpp v50, v48, v48 row_ror:8 row_mask:0xf bank_mask:0x3
  s_nop 1
  v_add_f32_dpp v50, v49, v49 row_ror:8 row_mask:0xf bank_mask:0xc
  s_nop 1
  v_add_f32_dpp v48, v50, v50 row_half_mirror row_mask:0xf bank_mask:0xf
  s_nop 1
  v_add_f32_dpp v48, v48, v48 quad_perm:[1,0,3,2] row_mask:0xf bank_mask:0xf
  s_nop 1
  v_add_f32_dpp v48, v48, v48 quad_perm:[2,3,0,1] row_mask:0xf bank_mask:0xf
  v_cvt_pk_bf16_f32 v48, v48, v48
  v_and_b32 v48, 0xffff0000, v48
  v_add_f32 v48, v185, v48
  v_cvt_pk_bf16_f32 v48, v48, v48
  buffer_store_short v48, v192, s[56:59], 0 offen
L_exit:
  s_endpgm
L_code_end:
.section .rodata,"a"
.p2align 6
.amdhsa_kernel sequential_preLN__gqa_block_cached__dense_activation_relu__decode_kernel
  .amdhsa_next_free_vgpr 512
  .amdhsa_next_free_sgpr 102
  .amdhsa_accum_offset 256
  .amdhsa_group_segment_fixed_size 0
  .amdhsa_kernarg_size 88
  .amdhsa_user_sgpr_count 2
  .amdhsa_user_sgpr_kernarg_segment_ptr 1
  .amdhsa_system_sgpr_workgroup_id_x 1
  .amdhsa_float_denorm_mode_32 3
.end_amdhsa_kernel
```
